```python
import torch

def _softmax(x, axis=-1):
    return torch.softmax(x, dim=axis)
def _gelu(x):
    return torch.nn.functional.gelu(x, approximate="tanh")
def _silu(x):
    return torch.nn.functional.silu(x)
def _sigmoid(x):
    return torch.sigmoid(x)
def _layernorm(x, axis=-1, eps=1e-5):
    m = x.mean(dim=axis, keepdim=True)
    v = x.var(dim=axis, keepdim=True, unbiased=False)
    return (x - m) / torch.sqrt(v + eps)
def _scatter_add(tgt, idx, src, axis=0):
    return tgt.clone().index_add_(axis, idx, src)
def _segment_sum(src, seg, n):
    out = torch.zeros((n,) + src.shape[1:], dtype=src.dtype)
    return out.index_add_(0, seg, src)
def _pad(x, pw):
    flat = tuple(v for pair in reversed(pw) for v in pair)
    return torch.nn.functional.pad(x, flat)

kernel_name = 'sequential_preLN__gqa_block_cached__glu_gated_swiglu__decode'

def setup_inputs():

    _w = (lambda a: (lambda t: t.to(torch.bfloat16) if t.is_floating_point() else t)(torch.as_tensor(a)))
    def _A_setup():
        B, Sq, D = 2, 1, 576
        Hq, Hkv, Sk, Dh = 32, 16, 32768, 128
        assert Hq % Hkv == 0, (Hq, Hkv)
        return {
            "x": _w((lambda *s: torch.randn(*s, dtype=torch.bfloat16) * 0.05)(B, Sq, D)),
            "k_cache": _w((lambda *s: torch.randn(*s, dtype=torch.bfloat16) * 3.2)(B, Hkv, Sk, Dh)),
            "v_cache": _w((lambda *s: torch.randn(*s, dtype=torch.bfloat16) * 1.6)(B, Hkv, Sk, Dh)),
            "wq": _w((lambda *s: torch.randn(*s, dtype=torch.bfloat16) * 3.2)(D, Hq * Dh) * (D ** -0.5)),
            "wo": _w((lambda *s: torch.randn(*s, dtype=torch.bfloat16) * 1.6)(Hq * Dh, D) * ((Hq * Dh) ** -0.5)),
        }
    _A_in = _A_setup()

    def _B_setup():
        B, S, D, F = 2, 1, 576, 4608
        return {
            "x": _w((lambda *s: torch.randn(*s, dtype=torch.bfloat16) * 0.05)(B, S, D)),
            "w1": _w((lambda *s: torch.randn(*s, dtype=torch.bfloat16) * 1.6)(D, F) * (2.0 / D) ** 0.5),
            "w3": _w((lambda *s: torch.randn(*s, dtype=torch.bfloat16) * 1.6)(D, F) * (2.0 / D) ** 0.5),
            "w2": _w((lambda *s: torch.randn(*s, dtype=torch.bfloat16) * 1.6)(F, D) * (2.0 / F) ** 0.5),
        }
    _B_in = _B_setup()

    return {
        "A_x": _A_in["x"],
        "A_k_cache": _A_in["k_cache"],
        "A_v_cache": _A_in["v_cache"],
        "A_wq": _A_in["wq"],
        "A_wo": _A_in["wo"],
        "B_x": _B_in["x"],
        "B_w1": _B_in["w1"],
        "B_w3": _B_in["w3"],
        "B_w2": _B_in["w2"],
    }

def reference(A_x, A_k_cache, A_v_cache, A_wq, A_wo, B_x, B_w1, B_w3, B_w2):
    def _A_ref(x, k_cache, v_cache, wq, wo):
        B, Sq, D = x.shape
        Hq, Dh = 32, 128
        Hkv = k_cache.shape[1]
        rep = Hq // Hkv
        q = (lambda x, *d: x.permute(*d))((x @ wq).reshape(B, Sq, Hq, Dh), 0, 2, 1, 3)
        k = (lambda x, n, axis: torch.repeat_interleave(x, n, dim=axis))(k_cache, rep, axis=1)
        v = (lambda x, n, axis: torch.repeat_interleave(x, n, dim=axis))(v_cache, rep, axis=1)
        scores = torch.einsum("bhqd,bhkd->bhqk", q, k) * (Dh ** -0.5)
        p = _softmax(scores, axis=-1)
        o = torch.einsum("bhqk,bhkd->bhqd", p, v)
        return (lambda x, *d: x.permute(*d))(o, 0, 2, 1, 3).reshape(B, Sq, Hq * Dh) @ wo

    def _B_ref(x, w1, w3, w2):
        gate = torch.einsum("bsd,df->bsf", x, w1)
        up = torch.einsum("bsd,df->bsf", x, w3)
        h = _silu(gate) * up
        out = torch.einsum("bsf,fd->bsd", h, w2)
        return out

    x = A_x
    h = x + _A_ref(_layernorm(x, axis=-1), A_k_cache, A_v_cache, A_wq, A_wo)
    h2 = h + _B_ref(_layernorm(h, axis=-1), B_w1, B_w3, B_w2)
    return h2
```

```asm
; @launch grid=(256,1,1) block=(256,1,1) lds=121920
.amdgcn_target "amdgcn-amd-amdhsa--gfx950"
.text
.globl sequential_preLN__gqa_block_cached__glu_gated_swiglu__decode_kernel
.p2align 8
.type sequential_preLN__gqa_block_cached__glu_gated_swiglu__decode_kernel,@function
sequential_preLN__gqa_block_cached__glu_gated_swiglu__decode_kernel:
    s_cmp_ge_u32 s2, 256
    s_cbranch_scc1 L_end
    s_load_dwordx2 s[4:5], s[0:1], 8
    s_load_dwordx2 s[8:9], s[0:1], 16
    s_load_dwordx2 s[16:17], s[0:1], 0
    s_load_dwordx2 s[20:21], s[0:1], 24
    s_load_dwordx2 s[12:13], s[0:1], 88
    s_load_dwordx2 s[24:25], s[0:1], 64
    s_load_dwordx2 s[28:29], s[0:1], 72
    s_load_dwordx2 s[94:95], s[0:1], 32
    s_load_dwordx4 s[96:99], s[0:1], 48
    s_getpc_b64 s[46:47]
L_pc:
    s_sub_u32 s46, s46, L_pc-sequential_preLN__gqa_block_cached__glu_gated_swiglu__decode_kernel
    s_subb_u32 s47, s47, 0
    v_lshlrev_b32 v97, 7, v0
    v_min_u32 v97, L_codeend-sequential_preLN__gqa_block_cached__glu_gated_swiglu__decode_kernel-4, v97
    global_load_dword v255, v97, s[46:47]
    v_lshrrev_b32 v2, 6, v0
    v_and_b32 v1, 63, v0
    v_readfirstlane_b32 s3, v2
    s_and_b32 s54, s2, 7
    s_lshr_b32 s55, s2, 3
    s_and_b32 s52, s55, 1
    s_lshr_b32 s53, s55, 1
    s_cmp_lt_u32 s3, 2
    s_cselect_b32 s68, 0, 1
    s_and_b32 s59, s3, 1
    s_mov_b32 s6, 0x10000000
    s_mov_b32 s7, 0x20000
    s_mov_b32 s10, 0x10000000
    s_mov_b32 s11, 0x20000
    v_bfe_u32 v2, v1, 2, 2
    v_lshlrev_b32 v2, 8, v2
    v_lshrrev_b32 v3, 4, v1
    v_lshl_or_b32 v2, v3, 6, v2
    v_and_b32 v3, 3, v1
    v_lshl_or_b32 v2, v3, 4, v2
    v_add_u32 v3, 4096, v2
    v_lshlrev_b32 v4, 4, v1
    v_add_u32 v5, 4096, v4
    s_lshl_b32 s51, s52, 4
    s_add_u32 s51, s51, s53
    s_lshl_b32 s51, s51, 23
    s_lshl_b32 s60, s54, 1
    s_add_u32 s60, s60, s59
    s_lshl_b32 s60, s60, 13
    s_add_u32 s32, s51, s60
    s_add_u32 s51, s51, 7602176
    s_waitcnt lgkmcnt(0)
    s_cmp_eq_u32 s68, 0
    s_cbranch_scc0 L_st1
    buffer_load_dwordx4 a[0:3], v2, s[4:7], s32 offen offset:0 nt
    buffer_load_dwordx4 a[4:7], v2, s[4:7], s32 offen offset:1024 nt
    buffer_load_dwordx4 a[8:11], v2, s[4:7], s32 offen offset:2048 nt
    buffer_load_dwordx4 a[12:15], v2, s[4:7], s32 offen offset:3072 nt
L_st1:
    v_add_u32 v254, 32768, v97
    v_min_u32 v254, L_codeend-sequential_preLN__gqa_block_cached__glu_gated_swiglu__decode_kernel-4, v254
    global_load_dword v255, v254, s[46:47]
    s_mov_b32 s14, 0x200000
    s_mov_b32 s15, 0x20000
    s_mov_b32 s18, 0x900
    s_mov_b32 s19, 0x20000
    s_mov_b32 s22, 0x480000
    s_mov_b32 s23, 0x20000
    s_mov_b32 s26, 0x510000
    s_mov_b32 s27, 0x20000
    s_mov_b32 s30, 0x900
    s_mov_b32 s31, 0x20000
    s_lshr_b32 s58, s3, 1
    s_mul_i32 s56, s58, 1152
    s_lshl_b32 s57, s59, 6
    s_add_u32 s57, s57, s56
    s_add_u32 s57, s57, 1024
    s_lshl_b32 s60, s59, 9
    s_add_u32 s56, s56, s60
    v_lshlrev_b32 v128, 3, v1
    v_and_b32 v129, 31, v1
    v_lshlrev_b32 v129, 1, v129
    v_lshrrev_b32 v130, 3, v1
    v_lshlrev_b32 v130, 13, v130
    v_bfe_u32 v131, v1, 4, 1
    s_lshl_b32 s60, s59, 1
    v_or_b32 v131, s60, v131
    v_lshlrev_b32 v131, 1, v131
    v_and_b32 v132, 7, v1
    v_xor_b32 v131, v131, v132
    v_lshl_or_b32 v130, v131, 4, v130
    s_and_b32 s58, s2, 3
    s_lshr_b32 s62, s2, 2
    s_lshl_b32 s62, s62, 7
    s_lshl_b32 s60, s58, 18
    s_add_u32 s62, s62, s60
    s_lshl_b32 s60, s3, 16
    s_add_u32 s62, s62, s60
    s_lshl_b32 s63, s3, 10
    v_mov_b32 v131, 0
    buffer_load_dwordx2 v[80:81], v128, s[16:19], s56 offen
    buffer_load_ushort v82, v129, s[16:19], s57 offen
    buffer_load_dword v136, v131, s[12:15], 0 offen sc1
    s_mov_b32 m0, s63
    s_nop 0
    buffer_load_dwordx4 v130, s[20:23], s62 offen nt lds
    s_add_u32 s62, s62, 0x100000
    s_add_u32 s63, s63, 4096
    s_mov_b32 m0, s63
    s_nop 0
    buffer_load_dwordx4 v130, s[20:23], s62 offen nt lds
    s_add_u32 s62, s62, 0x100000
    s_add_u32 s63, s63, 4096
    s_mov_b32 m0, s63
    s_nop 0
    buffer_load_dwordx4 v130, s[20:23], s62 offen nt lds
    s_add_u32 s62, s62, 0x100000
    s_add_u32 s63, s63, 4096
    s_mov_b32 m0, s63
    s_nop 0
    buffer_load_dwordx4 v130, s[20:23], s62 offen nt lds
    s_add_u32 s62, s62, 0x100000
    s_add_u32 s63, s63, 4096
    s_cmp_lt_u32 s58, 2
    s_cbranch_scc0 L_wq2
    s_mov_b32 m0, s63
    s_nop 0
    buffer_load_dwordx4 v130, s[20:23], s62 offen nt lds
    s_add_u32 s62, s62, 0x100000
    s_add_u32 s63, s63, 4096
L_wq2:
    v_lshrrev_b32 v250, 4, v1
    v_bfe_u32 v251, v1, 2, 2
    v_and_b32 v252, 3, v1
    v_and_b32 v253, 15, v1
    s_add_u32 s60, s56, 110592
    v_lshl_add_u32 v87, v1, 3, s60
    v_and_b32 v132, 31, v1
    s_add_u32 s60, s57, 110592
    v_lshl_add_u32 v88, v132, 1, s60
    s_lshl_b32 s60, s3, 4
    s_add_u32 s60, s60, 112896
    v_mov_b32 v89, s60
    s_lshr_b32 s60, s3, 1
    s_lshl_b32 s60, s60, 5
    s_add_u32 s60, s60, 112896
    v_mov_b32 v90, s60
    v_and_b32 v132, 1, v1
    v_mul_u32_u24 v132, 1152, v132
    v_lshl_add_u32 v132, v250, 4, v132
    v_add_u32 v91, 110592, v132
    s_lshl_b32 s60, s58, 6
    v_add_u32 v138, s60, v91
    v_lshrrev_b32 v132, 1, v251
    v_and_b32 v133, 1, v250
    v_lshl_or_b32 v132, v133, 1, v132
    v_xor_b32 v132, s3, v132
    v_lshlrev_b32 v132, 5, v132
    v_lshl_add_u32 v132, v252, 3, v132
    v_lshl_add_u32 v133, v250, 3, v251
    v_lshl_add_u32 v139, v133, 7, v132
    s_lshl_b32 s60, s2, 9
    s_lshl_b32 s61, s3, 7
    s_add_u32 s60, s60, s61
    s_add_u32 s60, s60, 1048576
    v_lshl_add_u32 v83, v253, 3, s60
    s_lshl_b32 s60, s54, 2
    s_add_u32 s60, s60, s55
    s_and_b32 s60, s60, 31
    s_and_b32 s61, s60, 3
    s_lshr_b32 s60, s60, 2
    s_cmp_lt_u32 s61, 2
    s_cbranch_scc0 L_role4
    s_mul_i32 s62, s61, 5
    s_lshl_b32 s63, s61, 1
    s_sub_u32 s63, s63, 5
    s_mov_b32 s61, 5
    s_branch L_role4x
L_role4:
    s_lshl_b32 s62, s61, 2
    s_sub_u32 s63, s62, 8
    s_add_u32 s62, s62, 2
    s_mov_b32 s61, 4
L_role4x:
    s_mov_b32 s35, 1
    s_mul_i32 s36, s54, 18
    s_add_u32 s36, s36, s62
    s_add_u32 s36, s36, s60
    s_mov_b32 s37, s61
    s_cmp_lt_u32 s60, s61
    s_cbranch_scc1 L_role3
    s_mov_b32 s35, 0
    s_mov_b32 s36, s54
    s_add_u32 s37, s63, s60
    s_add_u32 s60, s60, s61
    s_cmp_eq_u32 s60, 12
    s_cbranch_scc0 L_role3
    s_mov_b32 s35, 2
L_role3:
    s_lshl_b32 s60, s53, 1
    s_add_u32 s60, s60, s59
    s_lshl_b32 s61, s52, 3
    s_add_u32 s61, s61, s54
    s_lshl_b32 s62, s60, 12
    s_lshl_b32 s63, s61, 8
    s_add_u32 s62, s62, s63
    s_add_u32 s62, s62, 65536
    v_lshl_add_u32 v85, v1, 2, s62
    s_lshl_b32 s62, s60, 4
    s_add_u32 s62, s62, s61
    s_mul_i32 s62, s62, 128
    s_add_u32 s62, s62, 1441792
    v_mov_b32 v86, s62
    s_lshl_b32 s60, s55, 8
    s_add_u32 s60, s60, 4096
    v_mov_b32 v99, s60
    v_mov_b32 v132, 119296
    v_mov_b32 v133, 0
    ds_write_b32 v132, v133
    s_cmp_eq_u32 s68, 0
    s_cbranch_scc1 L_pf7
    v_mov_b32 v132, -1
    v_mov_b32 v133, -1
    v_mov_b32 v134, -1
    v_mov_b32 v135, -1
    buffer_store_dword v132, v85, s[12:15], 0 offen sc1
    buffer_store_dwordx2 v[132:133], v86, s[12:15], 0 offen sc1
    s_or_b32 s60, s54, s59
    s_cmp_eq_u32 s60, 0
    s_cbranch_scc0 L_pf5
    buffer_store_dword v131, v99, s[12:15], 0 offen sc1
L_pf5:
    s_cmp_eq_u32 s35, 0
    s_cbranch_scc0 L_pf6
    s_mul_i32 s60, s36, 4608
    s_mul_i32 s61, s59, 2304
    s_add_u32 s60, s60, s61
    s_mul_i32 s61, s37, 192
    s_add_u32 s60, s60, s61
    s_add_u32 s60, s60, 204800
    v_lshlrev_b32 v137, 2, v1
    s_mov_b32 exec_hi, 0xffff
    buffer_store_dword v132, v137, s[12:15], s60 offen sc1
    s_mov_b64 exec, -1
L_pf6:
    s_cmp_eq_u32 s35, 1
    s_cbranch_scc0 L_pf7
    s_lshl_b32 s60, s36, 7
    s_mul_i32 s61, s59, 331776
    s_add_u32 s60, s60, s61
    s_add_u32 s60, s60, 262144
    v_lshrrev_b32 v137, 3, v1
    v_mul_u32_u24 v137, 18432, v137
    v_and_b32 v130, 7, v1
    v_lshl_add_u32 v137, v130, 4, v137
    buffer_store_dwordx4 v[132:135], v137, s[12:15], s60 offen sc1
    s_add_u32 s60, s60, 147456
    buffer_store_dwordx4 v[132:135], v137, s[12:15], s60 offen sc1
    s_add_u32 s60, s60, 147456
    s_mov_b64 exec, 0xffff
    buffer_store_dwordx4 v[132:135], v137, s[12:15], s60 offen sc1
    s_add_u32 s60, s60, 147456
    s_mov_b64 exec, -1
L_pf7:
    s_cmp_eq_u32 s68, 0
    s_cbranch_scc1 L_w8
    s_waitcnt vmcnt(7)
    s_branch L_w9
L_w8:
    s_waitcnt vmcnt(5)
L_w9:
    s_cmp_eq_u32 s68, 0
    s_cbranch_scc0 L_st10
    buffer_load_dwordx4 a[16:19], v3, s[4:7], s32 offen offset:0 nt
    buffer_load_dwordx4 a[20:23], v3, s[4:7], s32 offen offset:1024 nt
    buffer_load_dwordx4 a[24:27], v3, s[4:7], s32 offen offset:2048 nt
    buffer_load_dwordx4 a[28:31], v3, s[4:7], s32 offen offset:3072 nt
L_st10:
    v_lshlrev_b32 v144, 16, v80
    v_and_b32 v145, 0xffff0000, v80
    v_lshlrev_b32 v146, 16, v81
    v_and_b32 v147, 0xffff0000, v81
    v_lshlrev_b32 v148, 16, v82
    v_readfirstlane_b32 s48, v144
    s_nop 1
    v_subrev_f32 v152, s48, v144
    v_subrev_f32 v153, s48, v145
    v_subrev_f32 v154, s48, v146
    v_subrev_f32 v155, s48, v147
    v_subrev_f32 v156, s48, v148
    v_mul_f32 v157, 0.5, v156
    v_add_f32 v158, v152, v153
    v_mul_f32 v159, v152, v152
    v_add_f32 v158, v158, v154
    v_fmac_f32 v159, v153, v153
    v_add_f32 v158, v158, v155
    v_fmac_f32 v159, v154, v154
    v_add_f32 v158, v158, v157
    v_fmac_f32 v159, v155, v155
    v_mov_b32 v160, s48
    v_fmac_f32 v159, v157, v156
    v_add_f32_dpp v158, v158, v158 quad_perm:[1,0,3,2] row_mask:0xf bank_mask:0xf
    s_nop 0
    v_add_f32_dpp v159, v159, v159 quad_perm:[1,0,3,2] row_mask:0xf bank_mask:0xf
    v_add_f32_dpp v158, v158, v158 quad_perm:[2,3,0,1] row_mask:0xf bank_mask:0xf
    s_nop 0
    v_add_f32_dpp v159, v159, v159 quad_perm:[2,3,0,1] row_mask:0xf bank_mask:0xf
    v_add_f32_dpp v158, v158, v158 row_half_mirror row_mask:0xf bank_mask:0xf
    s_nop 0
    v_add_f32_dpp v159, v159, v159 row_half_mirror row_mask:0xf bank_mask:0xf
    v_add_f32_dpp v158, v158, v158 row_mirror row_mask:0xf bank_mask:0xf
    s_nop 0
    v_add_f32_dpp v159, v159, v159 row_mirror row_mask:0xf bank_mask:0xf
    v_add_f32_dpp v158, v158, v158 row_bcast:15 row_mask:0xa bank_mask:0xf
    s_nop 0
    v_add_f32_dpp v159, v159, v159 row_bcast:15 row_mask:0xa bank_mask:0xf
    v_add_f32_dpp v158, v158, v158 row_bcast:31 row_mask:0xc bank_mask:0xf
    s_nop 0
    v_add_f32_dpp v159, v159, v159 row_bcast:31 row_mask:0xc bank_mask:0xf
    s_mov_b32 exec_lo, 0
    s_mov_b32 exec_hi, 0x80000000
    ds_write_b96 v89, v[158:160]
    s_mov_b64 exec, -1
    s_cmp_eq_u32 s68, 0
    s_cbranch_scc0 L_st11
    buffer_load_dwordx4 a[32:35], v4, s[8:11], s32 offen offset:0 nt
    buffer_load_dwordx4 a[36:39], v4, s[8:11], s32 offen offset:1024 nt
    buffer_load_dwordx4 a[40:43], v4, s[8:11], s32 offen offset:2048 nt
    buffer_load_dwordx4 a[44:47], v4, s[8:11], s32 offen offset:3072 nt
L_st11:
    s_waitcnt lgkmcnt(0)
    s_barrier
    ds_read_b96 v[162:164], v90
    ds_read_b96 v[166:168], v90 offset:16
    s_mov_b32 s48, 0x3b638e39
    s_mov_b32 s49, 0x43100000
    s_waitcnt lgkmcnt(0)
    v_mul_f32 v152, s48, v162
    v_mul_f32 v153, s48, v166
    v_fma_f32 v163, -v152, v162, v163
    v_fma_f32 v167, -v153, v166, v167
    v_add_f32 v152, v152, v164
    v_add_f32 v153, v153, v168
    v_add_f32 v163, v163, v167
    v_sub_f32 v162, v152, v153
    v_add_f32 v152, v152, v153
    v_mul_f32 v166, s49, v162
    v_mul_f32 v152, 0.5, v152
    v_fmac_f32 v163, v166, v162
    s_mov_b32 s48, 0x3ae38e39
    s_mov_b32 s49, 0x3727c5ac
    v_mul_f32 v163, s48, v163
    v_max_f32 v163, 0, v163
    v_cvt_pk_bf16_f32 v152, v152, v163
    v_and_b32 v159, 0xffff0000, v152
    v_lshlrev_b32 v158, 16, v152
    v_add_f32 v159, s49, v159
    v_sub_f32 v152, v144, v158
    v_cvt_pk_bf16_f32 v159, v159, v159
    v_sub_f32 v153, v145, v158
    v_lshlrev_b32 v159, 16, v159
    v_sub_f32 v154, v146, v158
    v_sqrt_f32 v159, v159
    v_sub_f32 v155, v147, v158
    v_sub_f32 v156, v148, v158
    v_cvt_pk_bf16_f32 v159, v159, v159
    v_cvt_pk_bf16_f32 v153, v152, v153
    v_lshlrev_b32 v159, 16, v159
    v_cvt_pk_bf16_f32 v155, v154, v155
    v_rcp_f32 v159, v159
    v_cvt_pk_bf16_f32 v156, v156, v156
    v_lshlrev_b32 v152, 16, v153
    v_and_b32 v153, 0xffff0000, v153
    v_lshlrev_b32 v154, 16, v155
    v_and_b32 v155, 0xffff0000, v155
    v_lshlrev_b32 v156, 16, v156
    v_mul_f32 v152, v152, v159
    v_mul_f32 v153, v153, v159
    v_mul_f32 v154, v154, v159
    v_mul_f32 v155, v155, v159
    v_mul_f32 v156, v156, v159
    v_cvt_pk_bf16_f32 v162, v152, v153
    v_cvt_pk_bf16_f32 v163, v154, v155
    v_cvt_pk_bf16_f32 v164, v156, v156
    ds_write_b64 v87, v[162:163]
    ds_write_b16 v88, v164
    s_cmp_eq_u32 s68, 0
    s_cbranch_scc1 L_w12
    s_waitcnt vmcnt(0)
    s_branch L_w13
L_w12:
    s_waitcnt vmcnt(8)
L_w13:
    v_readfirstlane_b32 s34, v136
    s_mul_i32 s34, s34, 0x9E3779B1
    s_add_u32 s34, s34, 0x7F4A7C15
    s_waitcnt lgkmcnt(0)
    s_barrier
    s_cmp_eq_u32 s68, 0
    s_cbranch_scc0 L_st14
    buffer_load_dwordx4 a[48:51], v5, s[8:11], s32 offen offset:0 nt
    buffer_load_dwordx4 a[52:55], v5, s[8:11], s32 offen offset:1024 nt
    buffer_load_dwordx4 a[56:59], v5, s[8:11], s32 offen offset:2048 nt
    buffer_load_dwordx4 a[60:63], v5, s[8:11], s32 offen offset:3072 nt
L_st14:
    ds_read_b128 v[176:179], v138 offset:0
    ds_read_b64_tr_b16 v[196:197], v139 offset:0
    ds_read_b64_tr_b16 v[198:199], v139 offset:512
    ds_read_b128 v[180:183], v138 offset:256
    ds_read_b64_tr_b16 v[200:201], v139 offset:4096
    ds_read_b64_tr_b16 v[202:203], v139 offset:4608
    ds_read_b128 v[184:187], v138 offset:512
    ds_read_b64_tr_b16 v[204:205], v139 offset:8192
    ds_read_b64_tr_b16 v[206:207], v139 offset:8704
    ds_read_b128 v[188:191], v138 offset:768
    ds_read_b64_tr_b16 v[208:209], v139 offset:12288
    ds_read_b64_tr_b16 v[210:211], v139 offset:12800
    ds_read_b128 v[192:195], v138 offset:1024
    ds_read_b64_tr_b16 v[212:213], v139 offset:16384
    ds_read_b64_tr_b16 v[214:215], v139 offset:16896
    s_waitcnt lgkmcnt(12)
    v_mfma_f32_16x16x32_bf16 v[216:219], v[176:179], v[196:199], 0
    s_waitcnt lgkmcnt(9)
    v_mfma_f32_16x16x32_bf16 v[216:219], v[180:183], v[200:203], v[216:219]
    s_waitcnt lgkmcnt(6)
    v_mfma_f32_16x16x32_bf16 v[216:219], v[184:187], v[204:207], v[216:219]
    s_waitcnt lgkmcnt(3)
    v_mfma_f32_16x16x32_bf16 v[216:219], v[188:191], v[208:211], v[216:219]
    s_waitcnt lgkmcnt(0)
    s_and_b32 s60, s2, 3
    s_cmp_lt_u32 s60, 2
    s_cbranch_scc0 L_q15
    v_mfma_f32_16x16x32_bf16 v[216:219], v[192:195], v[212:215], v[216:219]
L_q15:
    v_mov_b32 v177, s34
    v_mov_b32 v179, s34
    s_mov_b32 s60, 0x20000
    s_nop 4
    v_mov_b32 v176, v216
    v_mov_b32 v178, v217
    s_mov_b64 exec, 0xffff
    buffer_store_dwordx2 v[176:177], v83, s[12:15], 0 offen sc1
    buffer_store_dwordx2 v[178:179], v83, s[12:15], s60 offen sc1
    s_mov_b64 exec, -1
    s_mov_b32 s50, 65536
    s_cmp_eq_u32 s68, 0
    s_cbranch_scc0 L_hq16
    s_waitcnt vmcnt(6)
    s_add_u32 s32, s32, 131072
    buffer_load_dwordx4 a[64:67], v2, s[4:7], s32 offen offset:0 nt
    buffer_load_dwordx4 a[68:71], v2, s[4:7], s32 offen offset:1024 nt
    buffer_load_dwordx4 a[72:75], v2, s[4:7], s32 offen offset:2048 nt
    buffer_load_dwordx4 a[76:79], v2, s[4:7], s32 offen offset:3072 nt
    s_waitcnt vmcnt(6)
    buffer_load_dwordx4 a[80:83], v3, s[4:7], s32 offen offset:0 nt
    buffer_load_dwordx4 a[84:87], v3, s[4:7], s32 offen offset:1024 nt
    buffer_load_dwordx4 a[88:91], v3, s[4:7], s32 offen offset:2048 nt
    buffer_load_dwordx4 a[92:95], v3, s[4:7], s32 offen offset:3072 nt
    s_mov_b32 s38, 0x3db504f3
    s_mov_b32 s39, 0x3fb8aa3b
    s_mov_b32 s40, 0x22222222
    s_mov_b32 s41, 0x22222222
    s_mov_b32 s42, 0x44444444
    s_mov_b32 s43, 0x44444444
    s_mov_b32 s44, 0x88888888
    s_mov_b32 s45, 0x88888888
    s_mov_b32 s74, 0xff00ff00
    s_mov_b32 s75, 0xff00ff00
    s_mov_b32 s72, 0
    s_mov_b32 s73, -1
    v_mov_b32 v18, 0xff800000
    v_mov_b32 v19, 0
    v_mov_b32 v20, 0
    v_mov_b32 v21, 0
    v_mov_b32 v22, 0
    v_mov_b32 v23, 0
    v_bfe_u32 v132, v1, 3, 1
    v_mul_u32_u24 v132, 0x202, v132
    v_add_u32 v132, 0x100, v132
    v_or_b32 v133, 0x0c0c0000, v132
    v_lshlrev_b32 v132, 16, v132
    v_or_b32 v132, 0x0c0c, v132
    v_and_b32 v134, 1, v1
    v_cmp_eq_u32 vcc, 1, v134
    s_nop 1
    v_cndmask_b32 v132, v133, v132, vcc
    v_bfe_u32 v133, v1, 1, 2
    v_mov_b32 v134, 0x0c0c0c0c
    v_cmp_eq_u32 vcc, 0, v133
    s_nop 1
    v_cndmask_b32 v6, v134, v132, vcc
    v_cmp_eq_u32 vcc, 1, v133
    s_nop 1
    v_cndmask_b32 v7, v134, v132, vcc
    v_cmp_eq_u32 vcc, 2, v133
    s_nop 1
    v_cndmask_b32 v8, v134, v132, vcc
    v_cmp_eq_u32 vcc, 3, v133
    s_nop 1
    v_cndmask_b32 v9, v134, v132, vcc
    v_and_b32 v132, 1, v251
    v_lshlrev_b32 v132, 8, v132
    v_lshl_add_u32 v132, v250, 6, v132
    v_lshl_add_u32 v132, v252, 4, v132
    v_add_u32 v46, 112960, v132
    v_lshrrev_b32 v132, 1, v250
    v_lshlrev_b32 v133, 9, v132
    v_lshl_add_u32 v133, v253, 5, v133
    v_and_b32 v134, 1, v250
    v_lshl_add_u32 v133, v134, 4, v133
    s_lshl_b32 s60, s3, 10
    s_add_u32 s60, s60, 115200
    v_add_u32 v92, s60, v133
    v_lshlrev_b32 v132, 3, v132
    v_add_u32 v95, 113472, v132
    s_lshl_b32 s60, s3, 4
    v_bfe_u32 v132, v1, 2, 1
    v_lshlrev_b32 v132, 3, v132
    s_add_u32 s60, s60, 113472
    v_add_u32 v94, s60, v132
    v_lshlrev_b32 v132, 7, v250
    v_bfe_u32 v133, v1, 1, 1
    v_lshl_add_u32 v132, v133, 6, v132
    v_lshl_add_u32 v132, v251, 4, v132
    v_and_b32 v133, 1, v1
    v_lshl_add_u32 v132, v133, 3, v132
    s_lshl_b32 s60, s59, 9
    s_add_u32 s60, s60, 115200
    v_add_u32 v93, s60, v132
    s_waitcnt vmcnt(6)
    buffer_load_dwordx4 a[96:99], v4, s[8:11], s32 offen offset:0 nt
    buffer_load_dwordx4 a[100:103], v4, s[8:11], s32 offen offset:1024 nt
    buffer_load_dwordx4 a[104:107], v4, s[8:11], s32 offen offset:2048 nt
    buffer_load_dwordx4 a[108:111], v4, s[8:11], s32 offen offset:3072 nt
    s_waitcnt vmcnt(6)
    buffer_load_dwordx4 a[112:115], v5, s[8:11], s32 offen offset:0 nt
    buffer_load_dwordx4 a[116:119], v5, s[8:11], s32 offen offset:1024 nt
    buffer_load_dwordx4 a[120:123], v5, s[8:11], s32 offen offset:2048 nt
    buffer_load_dwordx4 a[124:127], v5, s[8:11], s32 offen offset:3072 nt
    s_cmp_eq_u32 s35, 0
    s_cbranch_scc0 L_rf20
    v_lshl_add_u32 v132, v250, 2, v251
    v_mul_u32_u24 v132, 96, v132
    v_lshl_add_u32 v132, v252, 3, v132
    s_mul_i32 s60, s3, 12288
    v_add_u32 v103, s60, v132
    s_lshl_b32 s61, s36, 2
    s_add_u32 s61, s61, s3
    v_lshlrev_b32 v132, 8, v253
    v_lshl_add_u32 v132, v250, 4, v132
    s_lshl_b32 s60, s61, 12
    s_add_u32 s60, s60, 65536
    v_add_u32 v104, s60, v132
    v_lshl_add_u32 v132, v250, 2, v253
    v_and_b32 v132, 7, v132
    v_lshrrev_b32 v133, 1, v250
    v_lshl_add_u32 v132, v133, 3, v132
    s_mul_i32 s60, s61, 2048
    s_add_u32 s60, s60, 1441792
    v_mad_u32_u24 v105, v132, 64, 0
    v_lshl_add_u32 v105, v105, 1, s60
    v_mul_u32_u24 v132, 192, v133
    v_lshl_add_u32 v132, v253, 2, v132
    s_mul_i32 s60, s3, 384
    s_add_u32 s60, s60, 113664
    v_add_u32 v132, s60, v132
    v_add_u32 v107, 128, v132
    v_and_b32 v133, 1, v250
    v_lshl_add_u32 v106, v133, 6, v132
    s_mul_i32 s60, s3, 192
    s_add_u32 s60, s60, 113664
    v_lshl_add_u32 v108, v1, 2, s60
    s_mul_i32 s60, s36, 4608
    s_mul_i32 s62, s3, 2304
    s_add_u32 s60, s60, s62
    s_mul_i32 s62, s37, 192
    s_add_u32 s60, s60, s62
    s_add_u32 s60, s60, 204800
    v_lshl_add_u32 v109, v1, 2, s60
    s_mul_i32 s60, s36, 9
    s_add_u32 s60, s60, s37
    s_and_b32 s61, s60, 1
    s_lshr_b32 s60, s60, 1
    s_min_u32 s60, s60, 35
    s_mul_i32 s76, s61, 576
    s_lshl_b32 s62, s60, 4
    s_add_u32 s76, s76, s62
    v_and_b32 v132, 7, v1
    v_mul_u32_u24 v133, 4608, v132
    v_bfe_u32 v134, v1, 3, 2
    v_lshl_add_u32 v133, v134, 4, v133
    s_lshl_b32 s62, s76, 2
    s_add_u32 s62, s62, 204800
    v_add_u32 v110, s62, v133
    v_lshlrev_b32 v114, 4, v134
    v_add_u32 v114, 119360, v114
    s_lshl_b32 s62, s76, 1
    v_lshl_add_u32 v112, v134, 3, s62
    v_lshl_add_u32 v117, v253, 1, s62
    s_mul_i32 s62, s60, 43
    s_lshr_b32 s62, s62, 7
    v_mul_u32_u24 v132, 12, v132
    v_add_u32 v132, s62, v132
    s_lshl_b32 s62, s54, 14
    s_add_u32 s62, s62, 1572864
    v_lshl_add_u32 v113, v132, 7, s62
    s_mul_i32 s60, s60, 18432
    s_lshl_b32 s61, s61, 6
    s_add_u32 s60, s60, s61
    s_mul_i32 s61, s3, 4608
    s_add_u32 s60, s60, s61
    s_add_u32 s60, s60, 262144
    v_lshlrev_b32 v132, 7, v250
    v_lshl_add_u32 v132, v251, 7, 0
    v_lshl_add_u32 v132, v250, 9, v132
    v_lshl_add_u32 v132, v252, 4, v132
    v_add_u32 v111, s60, v132
    s_lshl_b32 s60, s3, 8
    s_add_u32 s60, s60, 119424
    v_lshlrev_b32 v132, 6, v250
    v_lshl_add_u32 v132, v252, 4, v132
    v_add_u32 v115, s60, v132
    v_lshlrev_b32 v132, 8, v250
    v_lshl_add_u32 v132, v253, 2, v132
    v_add_u32 v116, 119424, v132
    s_lshl_b32 s60, s36, 1
    s_lshr_b32 s61, s3, 1
    s_add_u32 s60, s60, s61
    s_lshl_b32 s60, s60, 11
    s_add_u32 s60, s60, 16384
    v_lshl_add_u32 v119, v253, 7, s60
    s_mul_i32 s60, s36, 12
    s_add_u32 s60, s60, s37
    s_lshl_b32 s60, s60, 7
    s_add_u32 s60, s60, 1572864
    v_lshl_add_u32 v118, v1, 14, s60
    s_branch L_re21
L_rf20:
    s_cmp_eq_u32 s35, 1
    s_cbranch_scc0 L_re21
    v_and_b32 v132, 1, v250
    v_and_b32 v133, 2, v252
    v_or_b32 v132, v132, v133
    v_xor_b32 v132, s3, v132
    v_lshlrev_b32 v132, 4, v132
    v_lshl_add_u32 v132, v133, 10, v132
    v_and_b32 v133, 1, v252
    v_lshl_add_u32 v132, v133, 3, v132
    v_lshl_add_u32 v133, v250, 3, v251
    v_lshl_add_u32 v110, v133, 6, v132
    v_add_u32 v111, 36864, v110
    v_mul_u32_u24 v133, 1152, v133
    v_lshl_add_u32 v133, v252, 3, v133
    v_add_u32 v133, 73728, v133
    v_lshrrev_b32 v132, 1, v251
    v_and_b32 v134, 1, v250
    v_lshl_or_b32 v132, v134, 1, v132
    s_mul_i32 s60, s3, 9
    s_add_u32 s61, s60, 0
    v_xor_b32 v134, s61, v132
    v_lshl_add_u32 v112, v134, 5, v133
    s_add_u32 s61, s60, 1
    v_xor_b32 v134, s61, v132
    v_lshl_add_u32 v113, v134, 5, v133
    s_add_u32 s61, s60, 2
    v_xor_b32 v134, s61, v132
    v_lshl_add_u32 v114, v134, 5, v133
    s_add_u32 s61, s60, 3
    v_xor_b32 v134, s61, v132
    v_lshl_add_u32 v115, v134, 5, v133
    s_lshr_b32 s60, s3, 1
    s_mul_i32 s60, s60, 2304
    s_and_b32 s61, s3, 1
    s_lshl_b32 s62, s61, 10
    s_add_u32 s62, s62, s60
    s_add_u32 s62, s62, 204800
    v_lshl_add_u32 v116, v1, 4, s62
    s_lshl_b32 s62, s61, 7
    s_add_u32 s62, s62, s60
    s_add_u32 s62, s62, 206848
    v_and_b32 v132, 31, v1
    v_lshl_add_u32 v117, v132, 2, s62
    v_and_b32 v132, 7, v1
    s_mul_i32 s62, s61, 5
    v_add_u32 v133, s62, v132
    v_min_u32 v133, 11, v133
    v_add_u32 v134, 4, v132
    v_cmp_lt_u32 vcc, 5, v132
    s_cmp_eq_u32 s61, 0
    s_cselect_b64 vcc, vcc, 0
    v_cndmask_b32 v133, v133, v134, vcc
    v_lshrrev_b32 v132, 3, v1
    v_mul_u32_u24 v132, 12, v132
    v_add_u32 v132, v132, v133
    s_lshl_b32 s62, s54, 14
    s_add_u32 s62, s62, 1572864
    v_lshl_add_u32 v121, v132, 7, s62
    v_bfe_u32 v132, v1, 3, 1
    v_lshlrev_b32 v132, 6, v132
    v_and_b32 v133, 7, v1
    v_lshl_add_u32 v132, v133, 1, v132
    s_lshl_b32 s60, s3, 4
    s_add_u32 s60, s60, 113536
    v_add_u32 v118, s60, v132
    v_and_b32 v132, 1, v1
    v_lshlrev_b32 v133, 6, v132
    v_lshl_add_u32 v133, v250, 4, v133
    v_add_u32 v119, 113536, v133
    v_lshlrev_b32 v132, 6, v132
    v_lshl_add_u32 v132, v250, 4, v132
    s_mul_i32 s60, s3, 165888
    s_lshl_b32 s61, s36, 7
    s_add_u32 s60, s60, s61
    s_add_u32 s60, s60, 262144
    v_add_u32 v120, s60, v132
    s_mul_i32 s79, s36, 36864
    v_lshlrev_b32 v132, 4, v250
    v_add_u32 v132, 120640, v132
    v_cmp_gt_u32 vcc, 2, v253
    s_nop 1
    v_cndmask_b32 v122, v132, v91, vcc
    v_bfe_u32 v132, v1, 3, 1
    v_lshlrev_b32 v132, 5, v132
    v_add_u32 v123, 112896, v132
    v_lshrrev_b32 v133, 1, v253
    v_lshlrev_b32 v132, 4, v250
    v_add_u32 v132, 121856, v132
    v_cmp_eq_u32 vcc, 0, v133
    s_nop 1
    v_cndmask_b32 v224, v132, v119, vcc
    v_cmp_eq_u32 vcc, 1, v133
    s_nop 1
    v_cndmask_b32 v225, v132, v119, vcc
    v_cmp_eq_u32 vcc, 2, v133
    s_nop 1
    v_cndmask_b32 v226, v132, v119, vcc
    v_cmp_eq_u32 vcc, 3, v133
    s_nop 1
    v_cndmask_b32 v227, v132, v119, vcc
    v_cmp_eq_u32 vcc, 4, v133
    s_nop 1
    v_cndmask_b32 v228, v132, v119, vcc
    v_cmp_eq_u32 vcc, 5, v133
    s_nop 1
    v_cndmask_b32 v229, v132, v119, vcc
    v_cmp_eq_u32 vcc, 6, v133
    s_nop 1
    v_cndmask_b32 v230, v132, v119, vcc
    v_cmp_eq_u32 vcc, 7, v133
    s_nop 1
    v_cndmask_b32 v231, v132, v119, vcc
    v_mul_u32_u24 v133, 18432, v133
    v_add_u32 v232, v120, v133
    v_lshlrev_b32 v132, 2, v253
    v_add_u32 v132, 121856, v132
    v_mov_b32 v133, 0
    ds_write_b32 v132, v133
    v_lshlrev_b32 v132, 2, v0
    v_add_u32 v132, 120640, v132
    v_mov_b32 v133, 0x3f803f80
    ds_write_b32 v132, v133
    v_min_u32 v134, 31, v1
    v_lshlrev_b32 v134, 2, v134
    v_add_u32 v134, 121664, v134
    ds_write_b32 v134, v133
    s_mul_i32 s76, s59, 18432
    s_add_u32 s76, s76, 73728
L_re21:
    s_waitcnt vmcnt(6)
    s_add_u32 s32, s32, 131072
    buffer_load_dwordx4 a[128:131], v2, s[4:7], s32 offen offset:0 nt
    buffer_load_dwordx4 a[132:135], v2, s[4:7], s32 offen offset:1024 nt
    buffer_load_dwordx4 a[136:139], v2, s[4:7], s32 offen offset:2048 nt
    buffer_load_dwordx4 a[140:143], v2, s[4:7], s32 offen offset:3072 nt
    s_waitcnt vmcnt(6)
    buffer_load_dwordx4 a[144:147], v3, s[4:7], s32 offen offset:0 nt
    buffer_load_dwordx4 a[148:151], v3, s[4:7], s32 offen offset:1024 nt
    buffer_load_dwordx4 a[152:155], v3, s[4:7], s32 offen offset:2048 nt
    buffer_load_dwordx4 a[156:159], v3, s[4:7], s32 offen offset:3072 nt
    s_waitcnt vmcnt(6)
    buffer_load_dwordx4 a[160:163], v4, s[8:11], s32 offen offset:0 nt
    buffer_load_dwordx4 a[164:167], v4, s[8:11], s32 offen offset:1024 nt
    buffer_load_dwordx4 a[168:171], v4, s[8:11], s32 offen offset:2048 nt
    buffer_load_dwordx4 a[172:175], v4, s[8:11], s32 offen offset:3072 nt
    s_waitcnt vmcnt(6)
    buffer_load_dwordx4 a[176:179], v5, s[8:11], s32 offen offset:0 nt
    buffer_load_dwordx4 a[180:183], v5, s[8:11], s32 offen offset:1024 nt
    buffer_load_dwordx4 a[184:187], v5, s[8:11], s32 offen offset:2048 nt
    buffer_load_dwordx4 a[188:191], v5, s[8:11], s32 offen offset:3072 nt
    s_waitcnt vmcnt(6)
    s_add_u32 s32, s32, 131072
    buffer_load_dwordx4 a[192:195], v2, s[4:7], s32 offen offset:0 nt
    buffer_load_dwordx4 a[196:199], v2, s[4:7], s32 offen offset:1024 nt
    buffer_load_dwordx4 a[200:203], v2, s[4:7], s32 offen offset:2048 nt
    buffer_load_dwordx4 a[204:207], v2, s[4:7], s32 offen offset:3072 nt
    s_waitcnt vmcnt(6)
    buffer_load_dwordx4 a[208:211], v3, s[4:7], s32 offen offset:0 nt
    buffer_load_dwordx4 a[212:215], v3, s[4:7], s32 offen offset:1024 nt
    buffer_load_dwordx4 a[216:219], v3, s[4:7], s32 offen offset:2048 nt
    buffer_load_dwordx4 a[220:223], v3, s[4:7], s32 offen offset:3072 nt
    s_waitcnt vmcnt(6)
    buffer_load_dwordx4 a[224:227], v4, s[8:11], s32 offen offset:0 nt
    buffer_load_dwordx4 a[228:231], v4, s[8:11], s32 offen offset:1024 nt
    buffer_load_dwordx4 a[232:235], v4, s[8:11], s32 offen offset:2048 nt
    buffer_load_dwordx4 a[236:239], v4, s[8:11], s32 offen offset:3072 nt
    s_branch L_hq17
L_hq16:
    s_lshl_b32 s60, s52, 17
    s_lshl_b32 s61, s53, 13
    s_add_u32 s60, s60, s61
    s_lshl_b32 s61, s59, 12
    s_add_u32 s60, s60, s61
    s_add_u32 s60, s60, 1048576
    v_lshrrev_b32 v47, 5, v1
    v_lshlrev_b32 v47, 11, v47
    v_and_b32 v176, 31, v1
    v_lshl_add_u32 v47, v176, 4, v47
    v_add_u32 v47, s60, v47
    s_mov_b32 s38, 0x3db504f3
    s_mov_b32 s39, 0x3fb8aa3b
    s_mov_b32 s40, 0x22222222
    s_mov_b32 s41, 0x22222222
    s_mov_b32 s42, 0x44444444
    s_mov_b32 s43, 0x44444444
    s_mov_b32 s44, 0x88888888
    s_mov_b32 s45, 0x88888888
    s_mov_b32 s74, 0xff00ff00
    s_mov_b32 s75, 0xff00ff00
    s_mov_b32 s72, 0
    s_mov_b32 s73, -1
    v_mov_b32 v18, 0xff800000
    v_mov_b32 v19, 0
    v_mov_b32 v20, 0
    v_mov_b32 v21, 0
    v_mov_b32 v22, 0
    v_mov_b32 v23, 0
    v_bfe_u32 v132, v1, 3, 1
    v_mul_u32_u24 v132, 0x202, v132
    v_add_u32 v132, 0x100, v132
    v_or_b32 v133, 0x0c0c0000, v132
    v_lshlrev_b32 v132, 16, v132
    v_or_b32 v132, 0x0c0c, v132
    v_and_b32 v134, 1, v1
    v_cmp_eq_u32 vcc, 1, v134
    s_nop 1
    v_cndmask_b32 v132, v133, v132, vcc
    v_bfe_u32 v133, v1, 1, 2
    v_mov_b32 v134, 0x0c0c0c0c
    v_cmp_eq_u32 vcc, 0, v133
    s_nop 1
    v_cndmask_b32 v6, v134, v132, vcc
    v_cmp_eq_u32 vcc, 1, v133
    s_nop 1
    v_cndmask_b32 v7, v134, v132, vcc
    v_cmp_eq_u32 vcc, 2, v133
    s_nop 1
    v_cndmask_b32 v8, v134, v132, vcc
    v_cmp_eq_u32 vcc, 3, v133
    s_nop 1
    v_cndmask_b32 v9, v134, v132, vcc
    v_and_b32 v132, 1, v251
    v_lshlrev_b32 v132, 8, v132
    v_lshl_add_u32 v132, v250, 6, v132
    v_lshl_add_u32 v132, v252, 4, v132
    v_add_u32 v46, 112960, v132
    v_lshrrev_b32 v132, 1, v250
    v_lshlrev_b32 v133, 9, v132
    v_lshl_add_u32 v133, v253, 5, v133
    v_and_b32 v134, 1, v250
    v_lshl_add_u32 v133, v134, 4, v133
    s_lshl_b32 s60, s3, 10
    s_add_u32 s60, s60, 115200
    v_add_u32 v92, s60, v133
    v_lshlrev_b32 v132, 3, v132
    v_add_u32 v95, 113472, v132
    s_lshl_b32 s60, s3, 4
    v_bfe_u32 v132, v1, 2, 1
    v_lshlrev_b32 v132, 3, v132
    s_add_u32 s60, s60, 113472
    v_add_u32 v94, s60, v132
    v_lshlrev_b32 v132, 7, v250
    v_bfe_u32 v133, v1, 1, 1
    v_lshl_add_u32 v132, v133, 6, v132
    v_lshl_add_u32 v132, v251, 4, v132
    v_and_b32 v133, 1, v1
    v_lshl_add_u32 v132, v133, 3, v132
    s_lshl_b32 s60, s59, 9
    s_add_u32 s60, s60, 115200
    v_add_u32 v93, s60, v132
    s_cmp_eq_u32 s35, 0
    s_cbranch_scc0 L_rf23
    v_lshl_add_u32 v132, v250, 2, v251
    v_mul_u32_u24 v132, 96, v132
    v_lshl_add_u32 v132, v252, 3, v132
    s_mul_i32 s60, s3, 12288
    v_add_u32 v103, s60, v132
    s_lshl_b32 s61, s36, 2
    s_add_u32 s61, s61, s3
    v_lshlrev_b32 v132, 8, v253
    v_lshl_add_u32 v132, v250, 4, v132
    s_lshl_b32 s60, s61, 12
    s_add_u32 s60, s60, 65536
    v_add_u32 v104, s60, v132
    v_lshl_add_u32 v132, v250, 2, v253
    v_and_b32 v132, 7, v132
    v_lshrrev_b32 v133, 1, v250
    v_lshl_add_u32 v132, v133, 3, v132
    s_mul_i32 s60, s61, 2048
    s_add_u32 s60, s60, 1441792
    v_mad_u32_u24 v105, v132, 64, 0
    v_lshl_add_u32 v105, v105, 1, s60
    v_mul_u32_u24 v132, 192, v133
    v_lshl_add_u32 v132, v253, 2, v132
    s_mul_i32 s60, s3, 384
    s_add_u32 s60, s60, 113664
    v_add_u32 v132, s60, v132
    v_add_u32 v107, 128, v132
    v_and_b32 v133, 1, v250
    v_lshl_add_u32 v106, v133, 6, v132
    s_mul_i32 s60, s3, 192
    s_add_u32 s60, s60, 113664
    v_lshl_add_u32 v108, v1, 2, s60
    s_mul_i32 s60, s36, 4608
    s_mul_i32 s62, s3, 2304
    s_add_u32 s60, s60, s62
    s_mul_i32 s62, s37, 192
    s_add_u32 s60, s60, s62
    s_add_u32 s60, s60, 204800
    v_lshl_add_u32 v109, v1, 2, s60
    s_mul_i32 s60, s36, 9
    s_add_u32 s60, s60, s37
    s_and_b32 s61, s60, 1
    s_lshr_b32 s60, s60, 1
    s_min_u32 s60, s60, 35
    s_mul_i32 s76, s61, 576
    s_lshl_b32 s62, s60, 4
    s_add_u32 s76, s76, s62
    v_and_b32 v132, 7, v1
    v_mul_u32_u24 v133, 4608, v132
    v_bfe_u32 v134, v1, 3, 2
    v_lshl_add_u32 v133, v134, 4, v133
    s_lshl_b32 s62, s76, 2
    s_add_u32 s62, s62, 204800
    v_add_u32 v110, s62, v133
    v_lshlrev_b32 v114, 4, v134
    v_add_u32 v114, 119360, v114
    s_lshl_b32 s62, s76, 1
    v_lshl_add_u32 v112, v134, 3, s62
    v_lshl_add_u32 v117, v253, 1, s62
    s_mul_i32 s62, s60, 43
    s_lshr_b32 s62, s62, 7
    v_mul_u32_u24 v132, 12, v132
    v_add_u32 v132, s62, v132
    s_lshl_b32 s62, s54, 14
    s_add_u32 s62, s62, 1572864
    v_lshl_add_u32 v113, v132, 7, s62
    s_mul_i32 s60, s60, 18432
    s_lshl_b32 s61, s61, 6
    s_add_u32 s60, s60, s61
    s_mul_i32 s61, s3, 4608
    s_add_u32 s60, s60, s61
    s_add_u32 s60, s60, 262144
    v_lshlrev_b32 v132, 7, v250
    v_lshl_add_u32 v132, v251, 7, 0
    v_lshl_add_u32 v132, v250, 9, v132
    v_lshl_add_u32 v132, v252, 4, v132
    v_add_u32 v111, s60, v132
    s_lshl_b32 s60, s3, 8
    s_add_u32 s60, s60, 119424
    v_lshlrev_b32 v132, 6, v250
    v_lshl_add_u32 v132, v252, 4, v132
    v_add_u32 v115, s60, v132
    v_lshlrev_b32 v132, 8, v250
    v_lshl_add_u32 v132, v253, 2, v132
    v_add_u32 v116, 119424, v132
    s_lshl_b32 s60, s36, 1
    s_lshr_b32 s61, s3, 1
    s_add_u32 s60, s60, s61
    s_lshl_b32 s60, s60, 11
    s_add_u32 s60, s60, 16384
    v_lshl_add_u32 v119, v253, 7, s60
    s_mul_i32 s60, s36, 12
    s_add_u32 s60, s60, s37
    s_lshl_b32 s60, s60, 7
    s_add_u32 s60, s60, 1572864
    v_lshl_add_u32 v118, v1, 14, s60
    s_branch L_re24
L_rf23:
    s_cmp_eq_u32 s35, 1
    s_cbranch_scc0 L_re24
    v_and_b32 v132, 1, v250
    v_and_b32 v133, 2, v252
    v_or_b32 v132, v132, v133
    v_xor_b32 v132, s3, v132
    v_lshlrev_b32 v132, 4, v132
    v_lshl_add_u32 v132, v133, 10, v132
    v_and_b32 v133, 1, v252
    v_lshl_add_u32 v132, v133, 3, v132
    v_lshl_add_u32 v133, v250, 3, v251
    v_lshl_add_u32 v110, v133, 6, v132
    v_add_u32 v111, 36864, v110
    v_mul_u32_u24 v133, 1152, v133
    v_lshl_add_u32 v133, v252, 3, v133
    v_add_u32 v133, 73728, v133
    v_lshrrev_b32 v132, 1, v251
    v_and_b32 v134, 1, v250
    v_lshl_or_b32 v132, v134, 1, v132
    s_mul_i32 s60, s3, 9
    s_add_u32 s61, s60, 0
    v_xor_b32 v134, s61, v132
    v_lshl_add_u32 v112, v134, 5, v133
    s_add_u32 s61, s60, 1
    v_xor_b32 v134, s61, v132
    v_lshl_add_u32 v113, v134, 5, v133
    s_add_u32 s61, s60, 2
    v_xor_b32 v134, s61, v132
    v_lshl_add_u32 v114, v134, 5, v133
    s_add_u32 s61, s60, 3
    v_xor_b32 v134, s61, v132
    v_lshl_add_u32 v115, v134, 5, v133
    s_lshr_b32 s60, s3, 1
    s_mul_i32 s60, s60, 2304
    s_and_b32 s61, s3, 1
    s_lshl_b32 s62, s61, 10
    s_add_u32 s62, s62, s60
    s_add_u32 s62, s62, 204800
    v_lshl_add_u32 v116, v1, 4, s62
    s_lshl_b32 s62, s61, 7
    s_add_u32 s62, s62, s60
    s_add_u32 s62, s62, 206848
    v_and_b32 v132, 31, v1
    v_lshl_add_u32 v117, v132, 2, s62
    v_and_b32 v132, 7, v1
    s_mul_i32 s62, s61, 5
    v_add_u32 v133, s62, v132
    v_min_u32 v133, 11, v133
    v_add_u32 v134, 4, v132
    v_cmp_lt_u32 vcc, 5, v132
    s_cmp_eq_u32 s61, 0
    s_cselect_b64 vcc, vcc, 0
    v_cndmask_b32 v133, v133, v134, vcc
    v_lshrrev_b32 v132, 3, v1
    v_mul_u32_u24 v132, 12, v132
    v_add_u32 v132, v132, v133
    s_lshl_b32 s62, s54, 14
    s_add_u32 s62, s62, 1572864
    v_lshl_add_u32 v121, v132, 7, s62
    v_bfe_u32 v132, v1, 3, 1
    v_lshlrev_b32 v132, 6, v132
    v_and_b32 v133, 7, v1
    v_lshl_add_u32 v132, v133, 1, v132
    s_lshl_b32 s60, s3, 4
    s_add_u32 s60, s60, 113536
    v_add_u32 v118, s60, v132
    v_and_b32 v132, 1, v1
    v_lshlrev_b32 v133, 6, v132
    v_lshl_add_u32 v133, v250, 4, v133
    v_add_u32 v119, 113536, v133
    v_lshlrev_b32 v132, 6, v132
    v_lshl_add_u32 v132, v250, 4, v132
    s_mul_i32 s60, s3, 165888
    s_lshl_b32 s61, s36, 7
    s_add_u32 s60, s60, s61
    s_add_u32 s60, s60, 262144
    v_add_u32 v120, s60, v132
    s_mul_i32 s79, s36, 36864
    v_lshlrev_b32 v132, 4, v250
    v_add_u32 v132, 120640, v132
    v_cmp_gt_u32 vcc, 2, v253
    s_nop 1
    v_cndmask_b32 v122, v132, v91, vcc
    v_bfe_u32 v132, v1, 3, 1
    v_lshlrev_b32 v132, 5, v132
    v_add_u32 v123, 112896, v132
    v_lshrrev_b32 v133, 1, v253
    v_lshlrev_b32 v132, 4, v250
    v_add_u32 v132, 121856, v132
    v_cmp_eq_u32 vcc, 0, v133
    s_nop 1
    v_cndmask_b32 v224, v132, v119, vcc
    v_cmp_eq_u32 vcc, 1, v133
    s_nop 1
    v_cndmask_b32 v225, v132, v119, vcc
    v_cmp_eq_u32 vcc, 2, v133
    s_nop 1
    v_cndmask_b32 v226, v132, v119, vcc
    v_cmp_eq_u32 vcc, 3, v133
    s_nop 1
    v_cndmask_b32 v227, v132, v119, vcc
    v_cmp_eq_u32 vcc, 4, v133
    s_nop 1
    v_cndmask_b32 v228, v132, v119, vcc
    v_cmp_eq_u32 vcc, 5, v133
    s_nop 1
    v_cndmask_b32 v229, v132, v119, vcc
    v_cmp_eq_u32 vcc, 6, v133
    s_nop 1
    v_cndmask_b32 v230, v132, v119, vcc
    v_cmp_eq_u32 vcc, 7, v133
    s_nop 1
    v_cndmask_b32 v231, v132, v119, vcc
    v_mul_u32_u24 v133, 18432, v133
    v_add_u32 v232, v120, v133
    v_lshlrev_b32 v132, 2, v253
    v_add_u32 v132, 121856, v132
    v_mov_b32 v133, 0
    ds_write_b32 v132, v133
    v_lshlrev_b32 v132, 2, v0
    v_add_u32 v132, 120640, v132
    v_mov_b32 v133, 0x3f803f80
    ds_write_b32 v132, v133
    v_min_u32 v134, 31, v1
    v_lshlrev_b32 v134, 2, v134
    v_add_u32 v134, 121664, v134
    ds_write_b32 v134, v133
    s_mul_i32 s76, s59, 18432
    s_add_u32 s76, s76, 73728
L_re24:
    s_cmp_eq_u32 s35, 0
    s_cbranch_scc0 L_hf25
    s_mov_b32 s20, s94
    s_mov_b32 s21, s95
    s_mov_b32 s22, 4718592
    s_mov_b32 s23, 0x20000
    v_add_u32 v132, 0, v1
    v_mul_u32_u24 v133, 171, v132
    v_lshrrev_b32 v133, 10, v133
    v_mul_u32_u24 v134, 1056, v133
    v_lshl_add_u32 v100, v132, 4, v134
    v_add_u32 v132, 64, v1
    v_mul_u32_u24 v133, 171, v132
    v_lshrrev_b32 v133, 10, v133
    v_mul_u32_u24 v134, 1056, v133
    v_lshl_add_u32 v101, v132, 4, v134
    v_add_u32 v132, 128, v1
    v_mul_u32_u24 v133, 171, v132
    v_lshrrev_b32 v133, 10, v133
    v_mul_u32_u24 v134, 1056, v133
    v_lshl_add_u32 v102, v132, 4, v134
    s_lshl_b32 s61, s36, 2
    s_lshl_b32 s62, s59, 1
    s_add_u32 s61, s61, s62
    s_mul_i32 s77, s61, 147456
    s_mul_i32 s60, s37, 96
    s_add_u32 s77, s77, s60
    s_mul_i32 s78, s59, 24576
    buffer_load_dwordx4 v[176:179], v47, s[12:15], 0 offen offset:0 sc1
    buffer_load_dwordx4 v[180:183], v47, s[12:15], 0 offen offset:512 sc1
    buffer_load_dwordx4 v[184:187], v47, s[12:15], 0 offen offset:1024 sc1
    buffer_load_dwordx4 v[188:191], v47, s[12:15], 0 offen offset:1536 sc1
    s_add_u32 s62, s32, 655360
    s_lshl_b32 s63, s59, 14
    s_add_u32 s63, s63, 73728
    s_mov_b32 m0, s63
    s_add_u32 s63, s63, 4096
    buffer_load_dwordx4 v2, s[4:7], s62 offen offset:0 nt lds
    buffer_load_dwordx4 v2, s[4:7], s62 offen offset:1024 nt lds
    buffer_load_dwordx4 v2, s[4:7], s62 offen offset:2048 nt lds
    buffer_load_dwordx4 v2, s[4:7], s62 offen offset:3072 nt lds
    s_mov_b32 m0, s63
    s_add_u32 s63, s63, 4096
    buffer_load_dwordx4 v3, s[4:7], s62 offen offset:0 nt lds
    buffer_load_dwordx4 v3, s[4:7], s62 offen offset:1024 nt lds
    buffer_load_dwordx4 v3, s[4:7], s62 offen offset:2048 nt lds
    buffer_load_dwordx4 v3, s[4:7], s62 offen offset:3072 nt lds
    s_mov_b32 m0, s63
    s_add_u32 s63, s63, 4096
    buffer_load_dwordx4 v4, s[8:11], s62 offen offset:0 nt lds
    buffer_load_dwordx4 v4, s[8:11], s62 offen offset:1024 nt lds
    buffer_load_dwordx4 v4, s[8:11], s62 offen offset:2048 nt lds
    buffer_load_dwordx4 v4, s[8:11], s62 offen offset:3072 nt lds
    s_mov_b32 m0, s63
    s_add_u32 s63, s63, 4096
    buffer_load_dwordx4 v5, s[8:11], s62 offen offset:0 nt lds
    buffer_load_dwordx4 v5, s[8:11], s62 offen offset:1024 nt lds
    buffer_load_dwordx4 v5, s[8:11], s62 offen offset:2048 nt lds
    buffer_load_dwordx4 v5, s[8:11], s62 offen offset:3072 nt lds
    s_mov_b32 m0, s78
    s_nop 0
    buffer_load_dwordx4 v100, s[20:23], s77 offen nt lds
    s_add_u32 s78, s78, 1024
    s_mov_b32 m0, s78
    s_nop 0
    buffer_load_dwordx4 v101, s[20:23], s77 offen nt lds
    s_add_u32 s78, s78, 1024
    s_mov_b32 m0, s78
    s_nop 0
    buffer_load_dwordx4 v102, s[20:23], s77 offen nt lds
    s_add_u32 s78, s78, 1024
    s_add_u32 s77, s77, 36864
    s_mov_b32 m0, s78
    s_nop 0
    buffer_load_dwordx4 v100, s[20:23], s77 offen nt lds
    s_add_u32 s78, s78, 1024
    s_mov_b32 m0, s78
    s_nop 0
    buffer_load_dwordx4 v101, s[20:23], s77 offen nt lds
    s_add_u32 s78, s78, 1024
    s_mov_b32 m0, s78
    s_nop 0
    buffer_load_dwordx4 v102, s[20:23], s77 offen nt lds
    s_add_u32 s78, s78, 1024
    s_add_u32 s77, s77, 36864
    s_waitcnt vmcnt(22)
    s_branch L_hc27
L_hf25:
    s_cmp_eq_u32 s35, 1
    s_cbranch_scc0 L_hi26
    s_mov_b32 s20, s96
    s_mov_b32 s21, s97
    s_mov_b32 s64, s98
    s_mov_b32 s65, s99
    s_mov_b32 s22, 5308416
    s_mov_b32 s23, 0x20000
    s_mov_b32 s66, 5308416
    s_mov_b32 s67, 0x20000
    s_lshl_b32 s60, s59, 4
    v_lshrrev_b32 v132, 2, v1
    v_add_u32 v132, s60, v132
    v_bfe_u32 v133, v132, 3, 1
    v_xor_b32 v133, v252, v133
    v_mul_u32_u24 v132, 9216, v132
    v_lshl_add_u32 v200, v133, 4, v132
    v_xor_b32 v201, 32, v200
    s_lshl_b32 s77, s36, 6
    s_lshl_b32 s78, s59, 10
    buffer_load_dwordx4 v[176:179], v47, s[12:15], 0 offen offset:0 sc1
    buffer_load_dwordx4 v[180:183], v47, s[12:15], 0 offen offset:512 sc1
    buffer_load_dwordx4 v[184:187], v47, s[12:15], 0 offen offset:1024 sc1
    buffer_load_dwordx4 v[188:191], v47, s[12:15], 0 offen offset:1536 sc1
    s_add_u32 s62, s32, 655360
    s_lshl_b32 s63, s59, 14
    s_add_u32 s63, s63, 73728
    s_mov_b32 m0, s63
    s_add_u32 s63, s63, 4096
    buffer_load_dwordx4 v2, s[4:7], s62 offen offset:0 nt lds
    buffer_load_dwordx4 v2, s[4:7], s62 offen offset:1024 nt lds
    buffer_load_dwordx4 v2, s[4:7], s62 offen offset:2048 nt lds
    buffer_load_dwordx4 v2, s[4:7], s62 offen offset:3072 nt lds
    s_mov_b32 m0, s63
    s_add_u32 s63, s63, 4096
    buffer_load_dwordx4 v3, s[4:7], s62 offen offset:0 nt lds
    buffer_load_dwordx4 v3, s[4:7], s62 offen offset:1024 nt lds
    buffer_load_dwordx4 v3, s[4:7], s62 offen offset:2048 nt lds
    buffer_load_dwordx4 v3, s[4:7], s62 offen offset:3072 nt lds
    s_mov_b32 m0, s63
    s_add_u32 s63, s63, 4096
    buffer_load_dwordx4 v4, s[8:11], s62 offen offset:0 nt lds
    buffer_load_dwordx4 v4, s[8:11], s62 offen offset:1024 nt lds
    buffer_load_dwordx4 v4, s[8:11], s62 offen offset:2048 nt lds
    buffer_load_dwordx4 v4, s[8:11], s62 offen offset:3072 nt lds
    s_mov_b32 m0, s63
    s_add_u32 s63, s63, 4096
    buffer_load_dwordx4 v5, s[8:11], s62 offen offset:0 nt lds
    buffer_load_dwordx4 v5, s[8:11], s62 offen offset:1024 nt lds
    buffer_load_dwordx4 v5, s[8:11], s62 offen offset:2048 nt lds
    buffer_load_dwordx4 v5, s[8:11], s62 offen offset:3072 nt lds
    s_mov_b32 m0, s78
    s_add_u32 s60, s78, 2048
    buffer_load_dwordx4 v200, s[20:23], s77 offen nt lds
    s_mov_b32 m0, s60
    s_add_u32 s78, s78, 4096
    buffer_load_dwordx4 v201, s[64:67], s77 offen nt lds
    s_add_u32 s77, s77, 294912
    s_mov_b32 m0, s78
    s_add_u32 s60, s78, 2048
    buffer_load_dwordx4 v200, s[20:23], s77 offen nt lds
    s_mov_b32 m0, s60
    s_add_u32 s78, s78, 4096
    buffer_load_dwordx4 v201, s[64:67], s77 offen nt lds
    s_add_u32 s77, s77, 294912
    s_waitcnt vmcnt(20)
    s_branch L_hc27
L_hi26:
    buffer_load_dwordx4 v[176:179], v47, s[12:15], 0 offen offset:0 sc1
    buffer_load_dwordx4 v[180:183], v47, s[12:15], 0 offen offset:512 sc1
    buffer_load_dwordx4 v[184:187], v47, s[12:15], 0 offen offset:1024 sc1
    buffer_load_dwordx4 v[188:191], v47, s[12:15], 0 offen offset:1536 sc1
    s_add_u32 s62, s32, 655360
    s_lshl_b32 s63, s59, 14
    s_add_u32 s63, s63, 73728
    s_mov_b32 m0, s63
    s_add_u32 s63, s63, 4096
    buffer_load_dwordx4 v2, s[4:7], s62 offen offset:0 nt lds
    buffer_load_dwordx4 v2, s[4:7], s62 offen offset:1024 nt lds
    buffer_load_dwordx4 v2, s[4:7], s62 offen offset:2048 nt lds
    buffer_load_dwordx4 v2, s[4:7], s62 offen offset:3072 nt lds
    s_mov_b32 m0, s63
    s_add_u32 s63, s63, 4096
    buffer_load_dwordx4 v3, s[4:7], s62 offen offset:0 nt lds
    buffer_load_dwordx4 v3, s[4:7], s62 offen offset:1024 nt lds
    buffer_load_dwordx4 v3, s[4:7], s62 offen offset:2048 nt lds
    buffer_load_dwordx4 v3, s[4:7], s62 offen offset:3072 nt lds
    s_mov_b32 m0, s63
    s_add_u32 s63, s63, 4096
    buffer_load_dwordx4 v4, s[8:11], s62 offen offset:0 nt lds
    buffer_load_dwordx4 v4, s[8:11], s62 offen offset:1024 nt lds
    buffer_load_dwordx4 v4, s[8:11], s62 offen offset:2048 nt lds
    buffer_load_dwordx4 v4, s[8:11], s62 offen offset:3072 nt lds
    s_mov_b32 m0, s63
    s_add_u32 s63, s63, 4096
    buffer_load_dwordx4 v5, s[8:11], s62 offen offset:0 nt lds
    buffer_load_dwordx4 v5, s[8:11], s62 offen offset:1024 nt lds
    buffer_load_dwordx4 v5, s[8:11], s62 offen offset:2048 nt lds
    buffer_load_dwordx4 v5, s[8:11], s62 offen offset:3072 nt lds
    s_waitcnt vmcnt(16)
L_hc27:
    v_xor_b32 v192, s34, v177
    v_xor_b32 v193, s34, v179
    v_xor_b32 v194, s34, v181
    v_xor_b32 v195, s34, v183
    v_xor_b32 v196, s34, v185
    v_xor_b32 v197, s34, v187
    v_xor_b32 v198, s34, v189
    v_xor_b32 v199, s34, v191
    v_or3_b32 v192, v192, v193, v194
    v_or3_b32 v195, v195, v196, v197
    v_or3_b32 v192, v192, v198, v199
    v_or_b32 v192, v192, v195
    v_cmp_ne_u32 vcc, 0, v192
    s_cbranch_vccz L_qok28
    s_sub_u32 s50, s50, 1
    s_cbranch_scc1 L_qok28
    buffer_load_dwordx4 v[176:179], v47, s[12:15], 0 offen offset:0 sc1
    buffer_load_dwordx4 v[180:183], v47, s[12:15], 0 offen offset:512 sc1
    buffer_load_dwordx4 v[184:187], v47, s[12:15], 0 offen offset:1024 sc1
    buffer_load_dwordx4 v[188:191], v47, s[12:15], 0 offen offset:1536 sc1
    s_waitcnt vmcnt(0)
    s_branch L_hc27
L_qok28:
    v_add_f32 v176, v176, v180
    v_add_f32 v184, v184, v188
    v_add_f32 v176, v176, v184
    v_add_f32 v178, v178, v182
    v_add_f32 v186, v186, v190
    v_add_f32 v178, v178, v186
    v_cvt_pk_bf16_f32 v176, v176, v178
    s_lshl_b32 s60, s3, 8
    s_add_u32 s60, s60, 112448
    v_lshl_add_u32 v177, v1, 2, s60
    ds_write_b32 v177, v176
    s_waitcnt lgkmcnt(0)
    s_cmp_eq_u32 s35, 0
    s_cbranch_scc0 L_sw29
    s_waitcnt vmcnt(6)
    s_branch L_hq17
L_sw29:
    s_cmp_eq_u32 s35, 1
    s_cbranch_scc0 L_sw30
    s_waitcnt vmcnt(4)
    s_branch L_hq17
L_sw30:
    s_waitcnt vmcnt(0)
L_hq17:
    s_barrier
    s_cmp_eq_u32 s68, 0
    s_cbranch_scc0 L_help
    ds_read_b128 v[176:179], v46
    s_waitcnt lgkmcnt(0)
    v_cndmask_b32 v10, v176, 0, s[74:75]
    v_cndmask_b32 v14, 0, v176, s[74:75]
    v_cndmask_b32 v11, v177, 0, s[74:75]
    v_cndmask_b32 v15, 0, v177, s[74:75]
    v_cndmask_b32 v12, v178, 0, s[74:75]
    v_cndmask_b32 v16, 0, v178, s[74:75]
    v_cndmask_b32 v13, v179, 0, s[74:75]
    v_cndmask_b32 v17, 0, v179, s[74:75]
    s_lshl_b32 s48, s3, 14
    s_add_u32 s48, s48, 73728
    v_add_u32 v188, s48, v4
    s_waitcnt vmcnt(8)
    buffer_load_dwordx4 a[240:243], v5, s[8:11], s32 offen offset:0 nt
    buffer_load_dwordx4 a[244:247], v5, s[8:11], s32 offen offset:1024 nt
    buffer_load_dwordx4 a[248:251], v5, s[8:11], s32 offen offset:2048 nt
    buffer_load_dwordx4 a[252:255], v5, s[8:11], s32 offen offset:3072 nt
    v_mfma_f32_16x16x32_bf16 v[24:27], a[0:3], v[10:13], 0
    v_mfma_f32_16x16x32_bf16 v[24:27], a[4:7], v[14:17], v[24:27]
    v_mfma_f32_16x16x32_bf16 v[28:31], a[8:11], v[10:13], 0
    v_mfma_f32_16x16x32_bf16 v[28:31], a[12:15], v[14:17], v[28:31]
    v_mfma_f32_16x16x32_bf16 v[32:35], a[16:19], v[10:13], 0
    v_mfma_f32_16x16x32_bf16 v[32:35], a[20:23], v[14:17], v[32:35]
    v_mfma_f32_16x16x32_bf16 v[36:39], a[24:27], v[10:13], 0
    v_mfma_f32_16x16x32_bf16 v[36:39], a[28:31], v[14:17], v[36:39]
    s_nop 1
    v_mov_b32_dpp v40, v24 quad_perm:[0,0,0,0] row_mask:0xf bank_mask:0xf
    v_add_f32_dpp v40, v25, v40 quad_perm:[1,1,1,1] row_mask:0xf bank_mask:0xf
    v_add_f32_dpp v40, v26, v40 quad_perm:[2,2,2,2] row_mask:0xf bank_mask:0xf
    v_add_f32_dpp v40, v27, v40 quad_perm:[3,3,3,3] row_mask:0xf bank_mask:0xf
    v_mov_b32_dpp v41, v28 quad_perm:[0,0,0,0] row_mask:0xf bank_mask:0xf
    v_add_f32_dpp v41, v29, v41 quad_perm:[1,1,1,1] row_mask:0xf bank_mask:0xf
    v_add_f32_dpp v41, v30, v41 quad_perm:[2,2,2,2] row_mask:0xf bank_mask:0xf
    v_add_f32_dpp v41, v31, v41 quad_perm:[3,3,3,3] row_mask:0xf bank_mask:0xf
    v_mov_b32_dpp v42, v32 quad_perm:[0,0,0,0] row_mask:0xf bank_mask:0xf
    v_add_f32_dpp v42, v33, v42 quad_perm:[1,1,1,1] row_mask:0xf bank_mask:0xf
    v_add_f32_dpp v42, v34, v42 quad_perm:[2,2,2,2] row_mask:0xf bank_mask:0xf
    v_add_f32_dpp v42, v35, v42 quad_perm:[3,3,3,3] row_mask:0xf bank_mask:0xf
    v_mov_b32_dpp v43, v36 quad_perm:[0,0,0,0] row_mask:0xf bank_mask:0xf
    v_add_f32_dpp v43, v37, v43 quad_perm:[1,1,1,1] row_mask:0xf bank_mask:0xf
    v_add_f32_dpp v43, v38, v43 quad_perm:[2,2,2,2] row_mask:0xf bank_mask:0xf
    v_add_f32_dpp v43, v39, v43 quad_perm:[3,3,3,3] row_mask:0xf bank_mask:0xf
    v_cndmask_b32 v44, v40, v41, s[40:41]
    v_cndmask_b32 v44, v44, v42, s[42:43]
    v_cndmask_b32 v44, v44, v43, s[44:45]
    v_cvt_pk_bf16_f32 v44, v44, v44
    v_lshlrev_b32 v44, 16, v44
    v_mul_f32 v44, s38, v44
    v_cvt_pk_bf16_f32 v44, v44, v44
    v_lshlrev_b32 v44, 16, v44
    v_cmp_gt_f32 vcc, v44, v18
    s_cbranch_vccnz L_slow32
L_back33:
    v_sub_f32 v45, v44, v18
    v_mul_f32 v45, s39, v45
    v_exp_f32 v45, v45
    s_nop 0
    v_add_f32 v19, v19, v45
    v_mov_b32_dpp v46, v45 row_shl:4 row_mask:0xf bank_mask:0xf bound_ctrl:0
    v_cvt_pk_bf16_f32 v45, v45, v46
    s_nop 1
    v_mov_b32_dpp v40, v45 row_newbcast:0 row_mask:0xf bank_mask:0xf
    v_mov_b32_dpp v41, v45 row_newbcast:8 row_mask:0xf bank_mask:0xf
    v_mov_b32_dpp v42, v45 row_newbcast:1 row_mask:0xf bank_mask:0xf
    v_mov_b32_dpp v43, v45 row_newbcast:9 row_mask:0xf bank_mask:0xf
    v_perm_b32 v48, v40, v40, v6
    v_perm_b32 v49, v40, v40, v7
    v_perm_b32 v50, v40, v40, v8
    v_perm_b32 v51, v40, v40, v9
    v_perm_b32 v52, v41, v41, v6
    v_perm_b32 v53, v41, v41, v7
    v_perm_b32 v54, v41, v41, v8
    v_perm_b32 v55, v41, v41, v9
    v_perm_b32 v56, v42, v42, v6
    v_perm_b32 v57, v42, v42, v7
    v_perm_b32 v58, v42, v42, v8
    v_perm_b32 v59, v42, v42, v9
    v_perm_b32 v60, v43, v43, v6
    v_perm_b32 v61, v43, v43, v7
    v_perm_b32 v62, v43, v43, v8
    v_perm_b32 v63, v43, v43, v9
    v_mov_b32_dpp v40, v45 row_newbcast:2 row_mask:0xf bank_mask:0xf
    v_mov_b32_dpp v41, v45 row_newbcast:10 row_mask:0xf bank_mask:0xf
    v_mov_b32_dpp v42, v45 row_newbcast:3 row_mask:0xf bank_mask:0xf
    v_mov_b32_dpp v43, v45 row_newbcast:11 row_mask:0xf bank_mask:0xf
    v_perm_b32 v64, v40, v40, v6
    v_perm_b32 v65, v40, v40, v7
    v_perm_b32 v66, v40, v40, v8
    v_perm_b32 v67, v40, v40, v9
    v_perm_b32 v68, v41, v41, v6
    v_perm_b32 v69, v41, v41, v7
    v_perm_b32 v70, v41, v41, v8
    v_perm_b32 v71, v41, v41, v9
    v_perm_b32 v72, v42, v42, v6
    v_perm_b32 v73, v42, v42, v7
    v_perm_b32 v74, v42, v42, v8
    v_perm_b32 v75, v42, v42, v9
    v_perm_b32 v76, v43, v43, v6
    v_perm_b32 v77, v43, v43, v7
    v_perm_b32 v78, v43, v43, v8
    v_perm_b32 v79, v43, v43, v9
    v_mfma_f32_16x16x32_bf16 v[20:23], v[48:51], a[32:35], v[20:23]
    v_mfma_f32_16x16x32_bf16 v[20:23], v[52:55], a[36:39], v[20:23]
    v_mfma_f32_16x16x32_bf16 v[20:23], v[56:59], a[40:43], v[20:23]
    v_mfma_f32_16x16x32_bf16 v[20:23], v[60:63], a[44:47], v[20:23]
    v_mfma_f32_16x16x32_bf16 v[20:23], v[64:67], a[48:51], v[20:23]
    v_mfma_f32_16x16x32_bf16 v[20:23], v[68:71], a[52:55], v[20:23]
    v_mfma_f32_16x16x32_bf16 v[20:23], v[72:75], a[56:59], v[20:23]
    v_mfma_f32_16x16x32_bf16 v[20:23], v[76:79], a[60:63], v[20:23]
    s_waitcnt vmcnt(8)
    s_add_u32 s32, s32, 131072
    buffer_load_dwordx4 a[0:3], v2, s[4:7], s32 offen offset:0 nt
    buffer_load_dwordx4 a[4:7], v2, s[4:7], s32 offen offset:1024 nt
    buffer_load_dwordx4 a[8:11], v2, s[4:7], s32 offen offset:2048 nt
    buffer_load_dwordx4 a[12:15], v2, s[4:7], s32 offen offset:3072 nt
    v_mfma_f32_16x16x32_bf16 v[24:27], a[64:67], v[10:13], 0
    v_mfma_f32_16x16x32_bf16 v[24:27], a[68:71], v[14:17], v[24:27]
    v_mfma_f32_16x16x32_bf16 v[28:31], a[72:75], v[10:13], 0
    v_mfma_f32_16x16x32_bf16 v[28:31], a[76:79], v[14:17], v[28:31]
    ds_read_b128 a[64:67], v188 offset:0
    ds_read_b128 a[68:71], v188 offset:1024
    ds_read_b128 a[72:75], v188 offset:2048
    ds_read_b128 a[76:79], v188 offset:3072
    v_mfma_f32_16x16x32_bf16 v[32:35], a[80:83], v[10:13], 0
    v_mfma_f32_16x16x32_bf16 v[32:35], a[84:87], v[14:17], v[32:35]
    v_mfma_f32_16x16x32_bf16 v[36:39], a[88:91], v[10:13], 0
    v_mfma_f32_16x16x32_bf16 v[36:39], a[92:95], v[14:17], v[36:39]
    v_mov_b32_dpp v40, v24 quad_perm:[0,0,0,0] row_mask:0xf bank_mask:0xf
    v_add_f32_dpp v40, v25, v40 quad_perm:[1,1,1,1] row_mask:0xf bank_mask:0xf
    v_add_f32_dpp v40, v26, v40 quad_perm:[2,2,2,2] row_mask:0xf bank_mask:0xf
    v_add_f32_dpp v40, v27, v40 quad_perm:[3,3,3,3] row_mask:0xf bank_mask:0xf
    v_mov_b32_dpp v41, v28 quad_perm:[0,0,0,0] row_mask:0xf bank_mask:0xf
    v_add_f32_dpp v41, v29, v41 quad_perm:[1,1,1,1] row_mask:0xf bank_mask:0xf
    v_add_f32_dpp v41, v30, v41 quad_perm:[2,2,2,2] row_mask:0xf bank_mask:0xf
    v_add_f32_dpp v41, v31, v41 quad_perm:[3,3,3,3] row_mask:0xf bank_mask:0xf
    v_mov_b32_dpp v42, v32 quad_perm:[0,0,0,0] row_mask:0xf bank_mask:0xf
    v_add_f32_dpp v42, v33, v42 quad_perm:[1,1,1,1] row_mask:0xf bank_mask:0xf
    v_add_f32_dpp v42, v34, v42 quad_perm:[2,2,2,2] row_mask:0xf bank_mask:0xf
    v_add_f32_dpp v42, v35, v42 quad_perm:[3,3,3,3] row_mask:0xf bank_mask:0xf
    v_mov_b32_dpp v43, v36 quad_perm:[0,0,0,0] row_mask:0xf bank_mask:0xf
    v_add_f32_dpp v43, v37, v43 quad_perm:[1,1,1,1] row_mask:0xf bank_mask:0xf
    v_add_f32_dpp v43, v38, v43 quad_perm:[2,2,2,2] row_mask:0xf bank_mask:0xf
    v_add_f32_dpp v43, v39, v43 quad_perm:[3,3,3,3] row_mask:0xf bank_mask:0xf
    v_cndmask_b32 v44, v40, v41, s[40:41]
    v_cndmask_b32 v44, v44, v42, s[42:43]
    v_cndmask_b32 v44, v44, v43, s[44:45]
    v_cvt_pk_bf16_f32 v44, v44, v44
    v_lshlrev_b32 v44, 16, v44
    v_mul_f32 v44, s38, v44
    v_cvt_pk_bf16_f32 v44, v44, v44
    v_lshlrev_b32 v44, 16, v44
    v_cmp_gt_f32 vcc, v44, v18
    s_cbranch_vccnz L_slow35
L_back36:
    v_sub_f32 v45, v44, v18
    v_mul_f32 v45, s39, v45
    v_exp_f32 v45, v45
    s_nop 0
    v_add_f32 v19, v19, v45
    v_mov_b32_dpp v46, v45 row_shl:4 row_mask:0xf bank_mask:0xf bound_ctrl:0
    v_cvt_pk_bf16_f32 v45, v45, v46
    s_nop 1
    v_mov_b32_dpp v40, v45 row_newbcast:0 row_mask:0xf bank_mask:0xf
    v_mov_b32_dpp v41, v45 row_newbcast:8 row_mask:0xf bank_mask:0xf
    v_mov_b32_dpp v42, v45 row_newbcast:1 row_mask:0xf bank_mask:0xf
    v_mov_b32_dpp v43, v45 row_newbcast:9 row_mask:0xf bank_mask:0xf
    v_perm_b32 v48, v40, v40, v6
    v_perm_b32 v49, v40, v40, v7
    v_perm_b32 v50, v40, v40, v8
    v_perm_b32 v51, v40, v40, v9
    v_perm_b32 v52, v41, v41, v6
    v_perm_b32 v53, v41, v41, v7
    v_perm_b32 v54, v41, v41, v8
    v_perm_b32 v55, v41, v41, v9
    v_perm_b32 v56, v42, v42, v6
    v_perm_b32 v57, v42, v42, v7
    v_perm_b32 v58, v42, v42, v8
    v_perm_b32 v59, v42, v42, v9
    v_perm_b32 v60, v43, v43, v6
    v_perm_b32 v61, v43, v43, v7
    v_perm_b32 v62, v43, v43, v8
    v_perm_b32 v63, v43, v43, v9
    v_mov_b32_dpp v40, v45 row_newbcast:2 row_mask:0xf bank_mask:0xf
    v_mov_b32_dpp v41, v45 row_newbcast:10 row_mask:0xf bank_mask:0xf
    v_mov_b32_dpp v42, v45 row_newbcast:3 row_mask:0xf bank_mask:0xf
    v_mov_b32_dpp v43, v45 row_newbcast:11 row_mask:0xf bank_mask:0xf
    v_perm_b32 v64, v40, v40, v6
    v_perm_b32 v65, v40, v40, v7
    v_perm_b32 v66, v40, v40, v8
    v_perm_b32 v67, v40, v40, v9
    v_perm_b32 v68, v41, v41, v6
    v_perm_b32 v69, v41, v41, v7
    v_perm_b32 v70, v41, v41, v8
    v_perm_b32 v71, v41, v41, v9
    v_perm_b32 v72, v42, v42, v6
    v_perm_b32 v73, v42, v42, v7
    v_perm_b32 v74, v42, v42, v8
    v_perm_b32 v75, v42, v42, v9
    v_perm_b32 v76, v43, v43, v6
    v_perm_b32 v77, v43, v43, v7
    v_perm_b32 v78, v43, v43, v8
    v_perm_b32 v79, v43, v43, v9
    ds_read_b128 a[80:83], v188 offset:4096
    ds_read_b128 a[84:87], v188 offset:5120
    ds_read_b128 a[88:91], v188 offset:6144
    ds_read_b128 a[92:95], v188 offset:7168
    v_mfma_f32_16x16x32_bf16 v[20:23], v[48:51], a[96:99], v[20:23]
    v_mfma_f32_16x16x32_bf16 v[20:23], v[52:55], a[100:103], v[20:23]
    v_mfma_f32_16x16x32_bf16 v[20:23], v[56:59], a[104:107], v[20:23]
    v_mfma_f32_16x16x32_bf16 v[20:23], v[60:63], a[108:111], v[20:23]
    ds_read_b128 a[96:99], v188 offset:8192
    ds_read_b128 a[100:103], v188 offset:9216
    ds_read_b128 a[104:107], v188 offset:10240
    ds_read_b128 a[108:111], v188 offset:11264
    v_mfma_f32_16x16x32_bf16 v[20:23], v[64:67], a[112:115], v[20:23]
    v_mfma_f32_16x16x32_bf16 v[20:23], v[68:71], a[116:119], v[20:23]
    v_mfma_f32_16x16x32_bf16 v[20:23], v[72:75], a[120:123], v[20:23]
    v_mfma_f32_16x16x32_bf16 v[20:23], v[76:79], a[124:127], v[20:23]
    ds_read_b128 a[112:115], v188 offset:12288
    ds_read_b128 a[116:119], v188 offset:13312
    ds_read_b128 a[120:123], v188 offset:14336
    ds_read_b128 a[124:127], v188 offset:15360
    s_waitcnt vmcnt(8)
    buffer_load_dwordx4 a[16:19], v3, s[4:7], s32 offen offset:0 nt
    buffer_load_dwordx4 a[20:23], v3, s[4:7], s32 offen offset:1024 nt
    buffer_load_dwordx4 a[24:27], v3, s[4:7], s32 offen offset:2048 nt
    buffer_load_dwordx4 a[28:31], v3, s[4:7], s32 offen offset:3072 nt
    v_mfma_f32_16x16x32_bf16 v[24:27], a[128:131], v[10:13], 0
    v_mfma_f32_16x16x32_bf16 v[24:27], a[132:135], v[14:17], v[24:27]
    v_mfma_f32_16x16x32_bf16 v[28:31], a[136:139], v[10:13], 0
    v_mfma_f32_16x16x32_bf16 v[28:31], a[140:143], v[14:17], v[28:31]
    v_mfma_f32_16x16x32_bf16 v[32:35], a[144:147], v[10:13], 0
    v_mfma_f32_16x16x32_bf16 v[32:35], a[148:151], v[14:17], v[32:35]
    v_mfma_f32_16x16x32_bf16 v[36:39], a[152:155], v[10:13], 0
    v_mfma_f32_16x16x32_bf16 v[36:39], a[156:159], v[14:17], v[36:39]
    s_nop 1
    v_mov_b32_dpp v40, v24 quad_perm:[0,0,0,0] row_mask:0xf bank_mask:0xf
    v_add_f32_dpp v40, v25, v40 quad_perm:[1,1,1,1] row_mask:0xf bank_mask:0xf
    v_add_f32_dpp v40, v26, v40 quad_perm:[2,2,2,2] row_mask:0xf bank_mask:0xf
    v_add_f32_dpp v40, v27, v40 quad_perm:[3,3,3,3] row_mask:0xf bank_mask:0xf
    v_mov_b32_dpp v41, v28 quad_perm:[0,0,0,0] row_mask:0xf bank_mask:0xf
    v_add_f32_dpp v41, v29, v41 quad_perm:[1,1,1,1] row_mask:0xf bank_mask:0xf
    v_add_f32_dpp v41, v30, v41 quad_perm:[2,2,2,2] row_mask:0xf bank_mask:0xf
    v_add_f32_dpp v41, v31, v41 quad_perm:[3,3,3,3] row_mask:0xf bank_mask:0xf
    v_mov_b32_dpp v42, v32 quad_perm:[0,0,0,0] row_mask:0xf bank_mask:0xf
    v_add_f32_dpp v42, v33, v42 quad_perm:[1,1,1,1] row_mask:0xf bank_mask:0xf
    v_add_f32_dpp v42, v34, v42 quad_perm:[2,2,2,2] row_mask:0xf bank_mask:0xf
    v_add_f32_dpp v42, v35, v42 quad_perm:[3,3,3,3] row_mask:0xf bank_mask:0xf
    v_mov_b32_dpp v43, v36 quad_perm:[0,0,0,0] row_mask:0xf bank_mask:0xf
    v_add_f32_dpp v43, v37, v43 quad_perm:[1,1,1,1] row_mask:0xf bank_mask:0xf
    v_add_f32_dpp v43, v38, v43 quad_perm:[2,2,2,2] row_mask:0xf bank_mask:0xf
    v_add_f32_dpp v43, v39, v43 quad_perm:[3,3,3,3] row_mask:0xf bank_mask:0xf
    v_cndmask_b32 v44, v40, v41, s[40:41]
    v_cndmask_b32 v44, v44, v42, s[42:43]
    v_cndmask_b32 v44, v44, v43, s[44:45]
    v_cvt_pk_bf16_f32 v44, v44, v44
    v_lshlrev_b32 v44, 16, v44
    v_mul_f32 v44, s38, v44
    v_cvt_pk_bf16_f32 v44, v44, v44
    v_lshlrev_b32 v44, 16, v44
    v_cmp_gt_f32 vcc, v44, v18
    s_cbranch_vccnz L_slow38
L_back39:
    v_sub_f32 v45, v44, v18
    v_mul_f32 v45, s39, v45
    v_exp_f32 v45, v45
    s_nop 0
    v_add_f32 v19, v19, v45
    v_mov_b32_dpp v46, v45 row_shl:4 row_mask:0xf bank_mask:0xf bound_ctrl:0
    v_cvt_pk_bf16_f32 v45, v45, v46
    s_nop 1
    v_mov_b32_dpp v40, v45 row_newbcast:0 row_mask:0xf bank_mask:0xf
    v_mov_b32_dpp v41, v45 row_newbcast:8 row_mask:0xf bank_mask:0xf
    v_mov_b32_dpp v42, v45 row_newbcast:1 row_mask:0xf bank_mask:0xf
    v_mov_b32_dpp v43, v45 row_newbcast:9 row_mask:0xf bank_mask:0xf
    v_perm_b32 v48, v40, v40, v6
    v_perm_b32 v49, v40, v40, v7
    v_perm_b32 v50, v40, v40, v8
    v_perm_b32 v51, v40, v40, v9
    v_perm_b32 v52, v41, v41, v6
    v_perm_b32 v53, v41, v41, v7
    v_perm_b32 v54, v41, v41, v8
    v_perm_b32 v55, v41, v41, v9
    v_perm_b32 v56, v42, v42, v6
    v_perm_b32 v57, v42, v42, v7
    v_perm_b32 v58, v42, v42, v8
    v_perm_b32 v59, v42, v42, v9
    v_perm_b32 v60, v43, v43, v6
    v_perm_b32 v61, v43, v43, v7
    v_perm_b32 v62, v43, v43, v8
    v_perm_b32 v63, v43, v43, v9
    v_mov_b32_dpp v40, v45 row_newbcast:2 row_mask:0xf bank_mask:0xf
    v_mov_b32_dpp v41, v45 row_newbcast:10 row_mask:0xf bank_mask:0xf
    v_mov_b32_dpp v42, v45 row_newbcast:3 row_mask:0xf bank_mask:0xf
    v_mov_b32_dpp v43, v45 row_newbcast:11 row_mask:0xf bank_mask:0xf
    v_perm_b32 v64, v40, v40, v6
    v_perm_b32 v65, v40, v40, v7
    v_perm_b32 v66, v40, v40, v8
    v_perm_b32 v67, v40, v40, v9
    v_perm_b32 v68, v41, v41, v6
    v_perm_b32 v69, v41, v41, v7
    v_perm_b32 v70, v41, v41, v8
    v_perm_b32 v71, v41, v41, v9
    v_perm_b32 v72, v42, v42, v6
    v_perm_b32 v73, v42, v42, v7
    v_perm_b32 v74, v42, v42, v8
    v_perm_b32 v75, v42, v42, v9
    v_perm_b32 v76, v43, v43, v6
    v_perm_b32 v77, v43, v43, v7
    v_perm_b32 v78, v43, v43, v8
    v_perm_b32 v79, v43, v43, v9
    v_mfma_f32_16x16x32_bf16 v[20:23], v[48:51], a[160:163], v[20:23]
    v_mfma_f32_16x16x32_bf16 v[20:23], v[52:55], a[164:167], v[20:23]
    v_mfma_f32_16x16x32_bf16 v[20:23], v[56:59], a[168:171], v[20:23]
    v_mfma_f32_16x16x32_bf16 v[20:23], v[60:63], a[172:175], v[20:23]
    v_mfma_f32_16x16x32_bf16 v[20:23], v[64:67], a[176:179], v[20:23]
    v_mfma_f32_16x16x32_bf16 v[20:23], v[68:71], a[180:183], v[20:23]
    v_mfma_f32_16x16x32_bf16 v[20:23], v[72:75], a[184:187], v[20:23]
    v_mfma_f32_16x16x32_bf16 v[20:23], v[76:79], a[188:191], v[20:23]
    s_waitcnt vmcnt(8)
    buffer_load_dwordx4 a[32:35], v4, s[8:11], s32 offen offset:0 nt
    buffer_load_dwordx4 a[36:39], v4, s[8:11], s32 offen offset:1024 nt
    buffer_load_dwordx4 a[40:43], v4, s[8:11], s32 offen offset:2048 nt
    buffer_load_dwordx4 a[44:47], v4, s[8:11], s32 offen offset:3072 nt
    v_mfma_f32_16x16x32_bf16 v[24:27], a[192:195], v[10:13], 0
    v_mfma_f32_16x16x32_bf16 v[24:27], a[196:199], v[14:17], v[24:27]
    v_mfma_f32_16x16x32_bf16 v[28:31], a[200:203], v[10:13], 0
    v_mfma_f32_16x16x32_bf16 v[28:31], a[204:207], v[14:17], v[28:31]
    v_mfma_f32_16x16x32_bf16 v[32:35], a[208:211], v[10:13], 0
    v_mfma_f32_16x16x32_bf16 v[32:35], a[212:215], v[14:17], v[32:35]
    v_mfma_f32_16x16x32_bf16 v[36:39], a[216:219], v[10:13], 0
    v_mfma_f32_16x16x32_bf16 v[36:39], a[220:223], v[14:17], v[36:39]
    s_nop 1
    v_mov_b32_dpp v40, v24 quad_perm:[0,0,0,0] row_mask:0xf bank_mask:0xf
    v_add_f32_dpp v40, v25, v40 quad_perm:[1,1,1,1] row_mask:0xf bank_mask:0xf
    v_add_f32_dpp v40, v26, v40 quad_perm:[2,2,2,2] row_mask:0xf bank_mask:0xf
    v_add_f32_dpp v40, v27, v40 quad_perm:[3,3,3,3] row_mask:0xf bank_mask:0xf
    v_mov_b32_dpp v41, v28 quad_perm:[0,0,0,0] row_mask:0xf bank_mask:0xf
    v_add_f32_dpp v41, v29, v41 quad_perm:[1,1,1,1] row_mask:0xf bank_mask:0xf
    v_add_f32_dpp v41, v30, v41 quad_perm:[2,2,2,2] row_mask:0xf bank_mask:0xf
    v_add_f32_dpp v41, v31, v41 quad_perm:[3,3,3,3] row_mask:0xf bank_mask:0xf
    v_mov_b32_dpp v42, v32 quad_perm:[0,0,0,0] row_mask:0xf bank_mask:0xf
    v_add_f32_dpp v42, v33, v42 quad_perm:[1,1,1,1] row_mask:0xf bank_mask:0xf
    v_add_f32_dpp v42, v34, v42 quad_perm:[2,2,2,2] row_mask:0xf bank_mask:0xf
    v_add_f32_dpp v42, v35, v42 quad_perm:[3,3,3,3] row_mask:0xf bank_mask:0xf
    v_mov_b32_dpp v43, v36 quad_perm:[0,0,0,0] row_mask:0xf bank_mask:0xf
    v_add_f32_dpp v43, v37, v43 quad_perm:[1,1,1,1] row_mask:0xf bank_mask:0xf
    v_add_f32_dpp v43, v38, v43 quad_perm:[2,2,2,2] row_mask:0xf bank_mask:0xf
    v_add_f32_dpp v43, v39, v43 quad_perm:[3,3,3,3] row_mask:0xf bank_mask:0xf
    v_cndmask_b32 v44, v40, v41, s[40:41]
    v_cndmask_b32 v44, v44, v42, s[42:43]
    v_cndmask_b32 v44, v44, v43, s[44:45]
    v_cvt_pk_bf16_f32 v44, v44, v44
    v_lshlrev_b32 v44, 16, v44
    v_mul_f32 v44, s38, v44
    v_cvt_pk_bf16_f32 v44, v44, v44
    v_lshlrev_b32 v44, 16, v44
    v_cmp_gt_f32 vcc, v44, v18
    s_cbranch_vccnz L_slow41
L_back42:
    v_sub_f32 v45, v44, v18
    v_mul_f32 v45, s39, v45
    v_exp_f32 v45, v45
    s_nop 0
    v_add_f32 v19, v19, v45
    v_mov_b32_dpp v46, v45 row_shl:4 row_mask:0xf bank_mask:0xf bound_ctrl:0
    v_cvt_pk_bf16_f32 v45, v45, v46
    s_nop 1
    v_mov_b32_dpp v40, v45 row_newbcast:0 row_mask:0xf bank_mask:0xf
    v_mov_b32_dpp v41, v45 row_newbcast:8 row_mask:0xf bank_mask:0xf
    v_mov_b32_dpp v42, v45 row_newbcast:1 row_mask:0xf bank_mask:0xf
    v_mov_b32_dpp v43, v45 row_newbcast:9 row_mask:0xf bank_mask:0xf
    v_perm_b32 v48, v40, v40, v6
    v_perm_b32 v49, v40, v40, v7
    v_perm_b32 v50, v40, v40, v8
    v_perm_b32 v51, v40, v40, v9
    v_perm_b32 v52, v41, v41, v6
    v_perm_b32 v53, v41, v41, v7
    v_perm_b32 v54, v41, v41, v8
    v_perm_b32 v55, v41, v41, v9
    v_perm_b32 v56, v42, v42, v6
    v_perm_b32 v57, v42, v42, v7
    v_perm_b32 v58, v42, v42, v8
    v_perm_b32 v59, v42, v42, v9
    v_perm_b32 v60, v43, v43, v6
    v_perm_b32 v61, v43, v43, v7
    v_perm_b32 v62, v43, v43, v8
    v_perm_b32 v63, v43, v43, v9
    v_mov_b32_dpp v40, v45 row_newbcast:2 row_mask:0xf bank_mask:0xf
    v_mov_b32_dpp v41, v45 row_newbcast:10 row_mask:0xf bank_mask:0xf
    v_mov_b32_dpp v42, v45 row_newbcast:3 row_mask:0xf bank_mask:0xf
    v_mov_b32_dpp v43, v45 row_newbcast:11 row_mask:0xf bank_mask:0xf
    v_perm_b32 v64, v40, v40, v6
    v_perm_b32 v65, v40, v40, v7
    v_perm_b32 v66, v40, v40, v8
    v_perm_b32 v67, v40, v40, v9
    v_perm_b32 v68, v41, v41, v6
    v_perm_b32 v69, v41, v41, v7
    v_perm_b32 v70, v41, v41, v8
    v_perm_b32 v71, v41, v41, v9
    v_perm_b32 v72, v42, v42, v6
    v_perm_b32 v73, v42, v42, v7
    v_perm_b32 v74, v42, v42, v8
    v_perm_b32 v75, v42, v42, v9
    v_perm_b32 v76, v43, v43, v6
    v_perm_b32 v77, v43, v43, v7
    v_perm_b32 v78, v43, v43, v8
    v_perm_b32 v79, v43, v43, v9
    v_mfma_f32_16x16x32_bf16 v[20:23], v[48:51], a[224:227], v[20:23]
    v_mfma_f32_16x16x32_bf16 v[20:23], v[52:55], a[228:231], v[20:23]
    v_mfma_f32_16x16x32_bf16 v[20:23], v[56:59], a[232:235], v[20:23]
    v_mfma_f32_16x16x32_bf16 v[20:23], v[60:63], a[236:239], v[20:23]
    v_mfma_f32_16x16x32_bf16 v[20:23], v[64:67], a[240:243], v[20:23]
    v_mfma_f32_16x16x32_bf16 v[20:23], v[68:71], a[244:247], v[20:23]
    v_mfma_f32_16x16x32_bf16 v[20:23], v[72:75], a[248:251], v[20:23]
    v_mfma_f32_16x16x32_bf16 v[20:23], v[76:79], a[252:255], v[20:23]
    s_waitcnt vmcnt(8)
    buffer_load_dwordx4 a[48:51], v5, s[8:11], s32 offen offset:0 nt
    buffer_load_dwordx4 a[52:55], v5, s[8:11], s32 offen offset:1024 nt
    buffer_load_dwordx4 a[56:59], v5, s[8:11], s32 offen offset:2048 nt
    buffer_load_dwordx4 a[60:63], v5, s[8:11], s32 offen offset:3072 nt
    v_mfma_f32_16x16x32_bf16 v[24:27], a[0:3], v[10:13], 0
    v_mfma_f32_16x16x32_bf16 v[24:27], a[4:7], v[14:17], v[24:27]
    v_mfma_f32_16x16x32_bf16 v[28:31], a[8:11], v[10:13], 0
    v_mfma_f32_16x16x32_bf16 v[28:31], a[12:15], v[14:17], v[28:31]
    s_add_u32 s32, s32, 131072
    s_waitcnt vmcnt(8)
    s_add_u32 s32, s32, 131072
    buffer_load_dwordx4 a[0:3], v2, s[4:7], s32 offen offset:0 nt
    buffer_load_dwordx4 a[4:7], v2, s[4:7], s32 offen offset:1024 nt
    buffer_load_dwordx4 a[8:11], v2, s[4:7], s32 offen offset:2048 nt
    buffer_load_dwordx4 a[12:15], v2, s[4:7], s32 offen offset:3072 nt
    v_mfma_f32_16x16x32_bf16 v[32:35], a[16:19], v[10:13], 0
    v_mfma_f32_16x16x32_bf16 v[32:35], a[20:23], v[14:17], v[32:35]
    v_mfma_f32_16x16x32_bf16 v[36:39], a[24:27], v[10:13], 0
    v_mfma_f32_16x16x32_bf16 v[36:39], a[28:31], v[14:17], v[36:39]
    v_mov_b32_dpp v40, v24 quad_perm:[0,0,0,0] row_mask:0xf bank_mask:0xf
    v_add_f32_dpp v40, v25, v40 quad_perm:[1,1,1,1] row_mask:0xf bank_mask:0xf
    v_add_f32_dpp v40, v26, v40 quad_perm:[2,2,2,2] row_mask:0xf bank_mask:0xf
    v_add_f32_dpp v40, v27, v40 quad_perm:[3,3,3,3] row_mask:0xf bank_mask:0xf
    v_mov_b32_dpp v41, v28 quad_perm:[0,0,0,0] row_mask:0xf bank_mask:0xf
    v_add_f32_dpp v41, v29, v41 quad_perm:[1,1,1,1] row_mask:0xf bank_mask:0xf
    v_add_f32_dpp v41, v30, v41 quad_perm:[2,2,2,2] row_mask:0xf bank_mask:0xf
    v_add_f32_dpp v41, v31, v41 quad_perm:[3,3,3,3] row_mask:0xf bank_mask:0xf
    v_mov_b32_dpp v42, v32 quad_perm:[0,0,0,0] row_mask:0xf bank_mask:0xf
    v_add_f32_dpp v42, v33, v42 quad_perm:[1,1,1,1] row_mask:0xf bank_mask:0xf
    v_add_f32_dpp v42, v34, v42 quad_perm:[2,2,2,2] row_mask:0xf bank_mask:0xf
    v_add_f32_dpp v42, v35, v42 quad_perm:[3,3,3,3] row_mask:0xf bank_mask:0xf
    v_mov_b32_dpp v43, v36 quad_perm:[0,0,0,0] row_mask:0xf bank_mask:0xf
    v_add_f32_dpp v43, v37, v43 quad_perm:[1,1,1,1] row_mask:0xf bank_mask:0xf
    v_add_f32_dpp v43, v38, v43 quad_perm:[2,2,2,2] row_mask:0xf bank_mask:0xf
    v_add_f32_dpp v43, v39, v43 quad_perm:[3,3,3,3] row_mask:0xf bank_mask:0xf
    v_cndmask_b32 v44, v40, v41, s[40:41]
    v_cndmask_b32 v44, v44, v42, s[42:43]
    v_cndmask_b32 v44, v44, v43, s[44:45]
    v_cvt_pk_bf16_f32 v44, v44, v44
    v_lshlrev_b32 v44, 16, v44
    v_mul_f32 v44, s38, v44
    v_cvt_pk_bf16_f32 v44, v44, v44
    v_lshlrev_b32 v44, 16, v44
    v_cmp_gt_f32 vcc, v44, v18
    s_cbranch_vccnz L_slow45
L_back46:
    v_sub_f32 v45, v44, v18
    v_mul_f32 v45, s39, v45
    v_exp_f32 v45, v45
    s_nop 0
    v_add_f32 v19, v19, v45
    v_mov_b32_dpp v46, v45 row_shl:4 row_mask:0xf bank_mask:0xf bound_ctrl:0
    v_cvt_pk_bf16_f32 v45, v45, v46
    s_nop 1
    v_mov_b32_dpp v40, v45 row_newbcast:0 row_mask:0xf bank_mask:0xf
    v_mov_b32_dpp v41, v45 row_newbcast:8 row_mask:0xf bank_mask:0xf
    v_mov_b32_dpp v42, v45 row_newbcast:1 row_mask:0xf bank_mask:0xf
    v_mov_b32_dpp v43, v45 row_newbcast:9 row_mask:0xf bank_mask:0xf
    v_perm_b32 v48, v40, v40, v6
    v_perm_b32 v49, v40, v40, v7
    v_perm_b32 v50, v40, v40, v8
    v_perm_b32 v51, v40, v40, v9
    v_perm_b32 v52, v41, v41, v6
    v_perm_b32 v53, v41, v41, v7
    v_perm_b32 v54, v41, v41, v8
    v_perm_b32 v55, v41, v41, v9
    v_perm_b32 v56, v42, v42, v6
    v_perm_b32 v57, v42, v42, v7
    v_perm_b32 v58, v42, v42, v8
    v_perm_b32 v59, v42, v42, v9
    v_perm_b32 v60, v43, v43, v6
    v_perm_b32 v61, v43, v43, v7
    v_perm_b32 v62, v43, v43, v8
    v_perm_b32 v63, v43, v43, v9
    v_mov_b32_dpp v40, v45 row_newbcast:2 row_mask:0xf bank_mask:0xf
    v_mov_b32_dpp v41, v45 row_newbcast:10 row_mask:0xf bank_mask:0xf
    v_mov_b32_dpp v42, v45 row_newbcast:3 row_mask:0xf bank_mask:0xf
    v_mov_b32_dpp v43, v45 row_newbcast:11 row_mask:0xf bank_mask:0xf
    v_perm_b32 v64, v40, v40, v6
    v_perm_b32 v65, v40, v40, v7
    v_perm_b32 v66, v40, v40, v8
    v_perm_b32 v67, v40, v40, v9
    v_perm_b32 v68, v41, v41, v6
    v_perm_b32 v69, v41, v41, v7
    v_perm_b32 v70, v41, v41, v8
    v_perm_b32 v71, v41, v41, v9
    v_perm_b32 v72, v42, v42, v6
    v_perm_b32 v73, v42, v42, v7
    v_perm_b32 v74, v42, v42, v8
    v_perm_b32 v75, v42, v42, v9
    v_perm_b32 v76, v43, v43, v6
    v_perm_b32 v77, v43, v43, v7
    v_perm_b32 v78, v43, v43, v8
    v_perm_b32 v79, v43, v43, v9
    s_waitcnt vmcnt(8)
    buffer_load_dwordx4 a[16:19], v3, s[4:7], s32 offen offset:0 nt
    buffer_load_dwordx4 a[20:23], v3, s[4:7], s32 offen offset:1024 nt
    buffer_load_dwordx4 a[24:27], v3, s[4:7], s32 offen offset:2048 nt
    buffer_load_dwordx4 a[28:31], v3, s[4:7], s32 offen offset:3072 nt
    v_mfma_f32_16x16x32_bf16 v[20:23], v[48:51], a[32:35], v[20:23]
    v_mfma_f32_16x16x32_bf16 v[20:23], v[52:55], a[36:39], v[20:23]
    v_mfma_f32_16x16x32_bf16 v[20:23], v[56:59], a[40:43], v[20:23]
    v_mfma_f32_16x16x32_bf16 v[20:23], v[60:63], a[44:47], v[20:23]
    s_waitcnt vmcnt(8)
    buffer_load_dwordx4 a[32:35], v4, s[8:11], s32 offen offset:0 nt
    buffer_load_dwordx4 a[36:39], v4, s[8:11], s32 offen offset:1024 nt
    buffer_load_dwordx4 a[40:43], v4, s[8:11], s32 offen offset:2048 nt
    buffer_load_dwordx4 a[44:47], v4, s[8:11], s32 offen offset:3072 nt
    v_mfma_f32_16x16x32_bf16 v[20:23], v[64:67], a[48:51], v[20:23]
    v_mfma_f32_16x16x32_bf16 v[20:23], v[68:71], a[52:55], v[20:23]
    v_mfma_f32_16x16x32_bf16 v[20:23], v[72:75], a[56:59], v[20:23]
    v_mfma_f32_16x16x32_bf16 v[20:23], v[76:79], a[60:63], v[20:23]
    s_waitcnt lgkmcnt(0)
    v_mfma_f32_16x16x32_bf16 v[24:27], a[64:67], v[10:13], 0
    v_mfma_f32_16x16x32_bf16 v[24:27], a[68:71], v[14:17], v[24:27]
    v_mfma_f32_16x16x32_bf16 v[28:31], a[72:75], v[10:13], 0
    v_mfma_f32_16x16x32_bf16 v[28:31], a[76:79], v[14:17], v[28:31]
    v_mfma_f32_16x16x32_bf16 v[32:35], a[80:83], v[10:13], 0
    v_mfma_f32_16x16x32_bf16 v[32:35], a[84:87], v[14:17], v[32:35]
    v_mfma_f32_16x16x32_bf16 v[36:39], a[88:91], v[10:13], 0
    v_mfma_f32_16x16x32_bf16 v[36:39], a[92:95], v[14:17], v[36:39]
    s_nop 1
    v_mov_b32_dpp v40, v24 quad_perm:[0,0,0,0] row_mask:0xf bank_mask:0xf
    v_add_f32_dpp v40, v25, v40 quad_perm:[1,1,1,1] row_mask:0xf bank_mask:0xf
    v_add_f32_dpp v40, v26, v40 quad_perm:[2,2,2,2] row_mask:0xf bank_mask:0xf
    v_add_f32_dpp v40, v27, v40 quad_perm:[3,3,3,3] row_mask:0xf bank_mask:0xf
    v_mov_b32_dpp v41, v28 quad_perm:[0,0,0,0] row_mask:0xf bank_mask:0xf
    v_add_f32_dpp v41, v29, v41 quad_perm:[1,1,1,1] row_mask:0xf bank_mask:0xf
    v_add_f32_dpp v41, v30, v41 quad_perm:[2,2,2,2] row_mask:0xf bank_mask:0xf
    v_add_f32_dpp v41, v31, v41 quad_perm:[3,3,3,3] row_mask:0xf bank_mask:0xf
    v_mov_b32_dpp v42, v32 quad_perm:[0,0,0,0] row_mask:0xf bank_mask:0xf
    v_add_f32_dpp v42, v33, v42 quad_perm:[1,1,1,1] row_mask:0xf bank_mask:0xf
    v_add_f32_dpp v42, v34, v42 quad_perm:[2,2,2,2] row_mask:0xf bank_mask:0xf
    v_add_f32_dpp v42, v35, v42 quad_perm:[3,3,3,3] row_mask:0xf bank_mask:0xf
    v_mov_b32_dpp v43, v36 quad_perm:[0,0,0,0] row_mask:0xf bank_mask:0xf
    v_add_f32_dpp v43, v37, v43 quad_perm:[1,1,1,1] row_mask:0xf bank_mask:0xf
    v_add_f32_dpp v43, v38, v43 quad_perm:[2,2,2,2] row_mask:0xf bank_mask:0xf
    v_add_f32_dpp v43, v39, v43 quad_perm:[3,3,3,3] row_mask:0xf bank_mask:0xf
    v_cndmask_b32 v44, v40, v41, s[40:41]
    v_cndmask_b32 v44, v44, v42, s[42:43]
    v_cndmask_b32 v44, v44, v43, s[44:45]
    v_cvt_pk_bf16_f32 v44, v44, v44
    v_lshlrev_b32 v44, 16, v44
    v_mul_f32 v44, s38, v44
    v_cvt_pk_bf16_f32 v44, v44, v44
    v_lshlrev_b32 v44, 16, v44
    v_cmp_gt_f32 vcc, v44, v18
    s_cbranch_vccnz L_slow49
L_back50:
    v_sub_f32 v45, v44, v18
    v_mul_f32 v45, s39, v45
    v_exp_f32 v45, v45
    s_nop 0
    v_add_f32 v19, v19, v45
    v_mov_b32_dpp v46, v45 row_shl:4 row_mask:0xf bank_mask:0xf bound_ctrl:0
    v_cvt_pk_bf16_f32 v45, v45, v46
    s_nop 1
    v_mov_b32_dpp v40, v45 row_newbcast:0 row_mask:0xf bank_mask:0xf
    v_mov_b32_dpp v41, v45 row_newbcast:8 row_mask:0xf bank_mask:0xf
    v_mov_b32_dpp v42, v45 row_newbcast:1 row_mask:0xf bank_mask:0xf
    v_mov_b32_dpp v43, v45 row_newbcast:9 row_mask:0xf bank_mask:0xf
    v_perm_b32 v48, v40, v40, v6
    v_perm_b32 v49, v40, v40, v7
    v_perm_b32 v50, v40, v40, v8
    v_perm_b32 v51, v40, v40, v9
    v_perm_b32 v52, v41, v41, v6
    v_perm_b32 v53, v41, v41, v7
    v_perm_b32 v54, v41, v41, v8
    v_perm_b32 v55, v41, v41, v9
    v_perm_b32 v56, v42, v42, v6
    v_perm_b32 v57, v42, v42, v7
    v_perm_b32 v58, v42, v42, v8
    v_perm_b32 v59, v42, v42, v9
    v_perm_b32 v60, v43, v43, v6
    v_perm_b32 v61, v43, v43, v7
    v_perm_b32 v62, v43, v43, v8
    v_perm_b32 v63, v43, v43, v9
    v_mov_b32_dpp v40, v45 row_newbcast:2 row_mask:0xf bank_mask:0xf
    v_mov_b32_dpp v41, v45 row_newbcast:10 row_mask:0xf bank_mask:0xf
    v_mov_b32_dpp v42, v45 row_newbcast:3 row_mask:0xf bank_mask:0xf
    v_mov_b32_dpp v43, v45 row_newbcast:11 row_mask:0xf bank_mask:0xf
    v_perm_b32 v64, v40, v40, v6
    v_perm_b32 v65, v40, v40, v7
    v_perm_b32 v66, v40, v40, v8
    v_perm_b32 v67, v40, v40, v9
    v_perm_b32 v68, v41, v41, v6
    v_perm_b32 v69, v41, v41, v7
    v_perm_b32 v70, v41, v41, v8
    v_perm_b32 v71, v41, v41, v9
    v_perm_b32 v72, v42, v42, v6
    v_perm_b32 v73, v42, v42, v7
    v_perm_b32 v74, v42, v42, v8
    v_perm_b32 v75, v42, v42, v9
    v_perm_b32 v76, v43, v43, v6
    v_perm_b32 v77, v43, v43, v7
    v_perm_b32 v78, v43, v43, v8
    v_perm_b32 v79, v43, v43, v9
    v_mfma_f32_16x16x32_bf16 v[20:23], v[48:51], a[96:99], v[20:23]
    v_mfma_f32_16x16x32_bf16 v[20:23], v[52:55], a[100:103], v[20:23]
    v_mfma_f32_16x16x32_bf16 v[20:23], v[56:59], a[104:107], v[20:23]
    v_mfma_f32_16x16x32_bf16 v[20:23], v[60:63], a[108:111], v[20:23]
    s_waitcnt vmcnt(8)
    buffer_load_dwordx4 a[48:51], v5, s[8:11], s32 offen offset:0 nt
    buffer_load_dwordx4 a[52:55], v5, s[8:11], s32 offen offset:1024 nt
    buffer_load_dwordx4 a[56:59], v5, s[8:11], s32 offen offset:2048 nt
    buffer_load_dwordx4 a[60:63], v5, s[8:11], s32 offen offset:3072 nt
    v_mfma_f32_16x16x32_bf16 v[20:23], v[64:67], a[112:115], v[20:23]
    v_mfma_f32_16x16x32_bf16 v[20:23], v[68:71], a[116:119], v[20:23]
    v_mfma_f32_16x16x32_bf16 v[20:23], v[72:75], a[120:123], v[20:23]
    v_mfma_f32_16x16x32_bf16 v[20:23], v[76:79], a[124:127], v[20:23]
    v_mfma_f32_16x16x32_bf16 v[24:27], a[0:3], v[10:13], 0
    v_mfma_f32_16x16x32_bf16 v[24:27], a[4:7], v[14:17], v[24:27]
    v_mfma_f32_16x16x32_bf16 v[28:31], a[8:11], v[10:13], 0
    v_mfma_f32_16x16x32_bf16 v[28:31], a[12:15], v[14:17], v[28:31]
    s_waitcnt vmcnt(8)
    s_add_u32 s32, s32, 131072
    buffer_load_dwordx4 a[64:67], v2, s[4:7], s32 offen offset:0 nt
    buffer_load_dwordx4 a[68:71], v2, s[4:7], s32 offen offset:1024 nt
    buffer_load_dwordx4 a[72:75], v2, s[4:7], s32 offen offset:2048 nt
    buffer_load_dwordx4 a[76:79], v2, s[4:7], s32 offen offset:3072 nt
    v_mfma_f32_16x16x32_bf16 v[32:35], a[16:19], v[10:13], 0
    v_mfma_f32_16x16x32_bf16 v[32:35], a[20:23], v[14:17], v[32:35]
    v_mfma_f32_16x16x32_bf16 v[36:39], a[24:27], v[10:13], 0
    v_mfma_f32_16x16x32_bf16 v[36:39], a[28:31], v[14:17], v[36:39]
    v_mov_b32_dpp v40, v24 quad_perm:[0,0,0,0] row_mask:0xf bank_mask:0xf
    v_add_f32_dpp v40, v25, v40 quad_perm:[1,1,1,1] row_mask:0xf bank_mask:0xf
    v_add_f32_dpp v40, v26, v40 quad_perm:[2,2,2,2] row_mask:0xf bank_mask:0xf
    v_add_f32_dpp v40, v27, v40 quad_perm:[3,3,3,3] row_mask:0xf bank_mask:0xf
    v_mov_b32_dpp v41, v28 quad_perm:[0,0,0,0] row_mask:0xf bank_mask:0xf
    v_add_f32_dpp v41, v29, v41 quad_perm:[1,1,1,1] row_mask:0xf bank_mask:0xf
    v_add_f32_dpp v41, v30, v41 quad_perm:[2,2,2,2] row_mask:0xf bank_mask:0xf
    v_add_f32_dpp v41, v31, v41 quad_perm:[3,3,3,3] row_mask:0xf bank_mask:0xf
    v_mov_b32_dpp v42, v32 quad_perm:[0,0,0,0] row_mask:0xf bank_mask:0xf
    v_add_f32_dpp v42, v33, v42 quad_perm:[1,1,1,1] row_mask:0xf bank_mask:0xf
    v_add_f32_dpp v42, v34, v42 quad_perm:[2,2,2,2] row_mask:0xf bank_mask:0xf
    v_add_f32_dpp v42, v35, v42 quad_perm:[3,3,3,3] row_mask:0xf bank_mask:0xf
    v_mov_b32_dpp v43, v36 quad_perm:[0,0,0,0] row_mask:0xf bank_mask:0xf
    v_add_f32_dpp v43, v37, v43 quad_perm:[1,1,1,1] row_mask:0xf bank_mask:0xf
    v_add_f32_dpp v43, v38, v43 quad_perm:[2,2,2,2] row_mask:0xf bank_mask:0xf
    v_add_f32_dpp v43, v39, v43 quad_perm:[3,3,3,3] row_mask:0xf bank_mask:0xf
    v_cndmask_b32 v44, v40, v41, s[40:41]
    v_cndmask_b32 v44, v44, v42, s[42:43]
    v_cndmask_b32 v44, v44, v43, s[44:45]
    v_cvt_pk_bf16_f32 v44, v44, v44
    v_lshlrev_b32 v44, 16, v44
    v_mul_f32 v44, s38, v44
    v_cvt_pk_bf16_f32 v44, v44, v44
    v_lshlrev_b32 v44, 16, v44
    v_cmp_gt_f32 vcc, v44, v18
    s_cbranch_vccnz L_slow53
L_back54:
    v_sub_f32 v45, v44, v18
    v_mul_f32 v45, s39, v45
    v_exp_f32 v45, v45
    s_nop 0
    v_add_f32 v19, v19, v45
    v_mov_b32_dpp v46, v45 row_shl:4 row_mask:0xf bank_mask:0xf bound_ctrl:0
    v_cvt_pk_bf16_f32 v45, v45, v46
    s_nop 1
    v_mov_b32_dpp v40, v45 row_newbcast:0 row_mask:0xf bank_mask:0xf
    v_mov_b32_dpp v41, v45 row_newbcast:8 row_mask:0xf bank_mask:0xf
    v_mov_b32_dpp v42, v45 row_newbcast:1 row_mask:0xf bank_mask:0xf
    v_mov_b32_dpp v43, v45 row_newbcast:9 row_mask:0xf bank_mask:0xf
    v_perm_b32 v48, v40, v40, v6
    v_perm_b32 v49, v40, v40, v7
    v_perm_b32 v50, v40, v40, v8
    v_perm_b32 v51, v40, v40, v9
    v_perm_b32 v52, v41, v41, v6
    v_perm_b32 v53, v41, v41, v7
    v_perm_b32 v54, v41, v41, v8
    v_perm_b32 v55, v41, v41, v9
    v_perm_b32 v56, v42, v42, v6
    v_perm_b32 v57, v42, v42, v7
    v_perm_b32 v58, v42, v42, v8
    v_perm_b32 v59, v42, v42, v9
    v_perm_b32 v60, v43, v43, v6
    v_perm_b32 v61, v43, v43, v7
    v_perm_b32 v62, v43, v43, v8
    v_perm_b32 v63, v43, v43, v9
    v_mov_b32_dpp v40, v45 row_newbcast:2 row_mask:0xf bank_mask:0xf
    v_mov_b32_dpp v41, v45 row_newbcast:10 row_mask:0xf bank_mask:0xf
    v_mov_b32_dpp v42, v45 row_newbcast:3 row_mask:0xf bank_mask:0xf
    v_mov_b32_dpp v43, v45 row_newbcast:11 row_mask:0xf bank_mask:0xf
    v_perm_b32 v64, v40, v40, v6
    v_perm_b32 v65, v40, v40, v7
    v_perm_b32 v66, v40, v40, v8
    v_perm_b32 v67, v40, v40, v9
    v_perm_b32 v68, v41, v41, v6
    v_perm_b32 v69, v41, v41, v7
    v_perm_b32 v70, v41, v41, v8
    v_perm_b32 v71, v41, v41, v9
    v_perm_b32 v72, v42, v42, v6
    v_perm_b32 v73, v42, v42, v7
    v_perm_b32 v74, v42, v42, v8
    v_perm_b32 v75, v42, v42, v9
    v_perm_b32 v76, v43, v43, v6
    v_perm_b32 v77, v43, v43, v7
    v_perm_b32 v78, v43, v43, v8
    v_perm_b32 v79, v43, v43, v9
    s_waitcnt vmcnt(8)
    buffer_load_dwordx4 a[80:83], v3, s[4:7], s32 offen offset:0 nt
    buffer_load_dwordx4 a[84:87], v3, s[4:7], s32 offen offset:1024 nt
    buffer_load_dwordx4 a[88:91], v3, s[4:7], s32 offen offset:2048 nt
    buffer_load_dwordx4 a[92:95], v3, s[4:7], s32 offen offset:3072 nt
    v_mfma_f32_16x16x32_bf16 v[20:23], v[48:51], a[32:35], v[20:23]
    v_mfma_f32_16x16x32_bf16 v[20:23], v[52:55], a[36:39], v[20:23]
    v_mfma_f32_16x16x32_bf16 v[20:23], v[56:59], a[40:43], v[20:23]
    v_mfma_f32_16x16x32_bf16 v[20:23], v[60:63], a[44:47], v[20:23]
    s_waitcnt vmcnt(8)
    buffer_load_dwordx4 a[96:99], v4, s[8:11], s32 offen offset:0 nt
    buffer_load_dwordx4 a[100:103], v4, s[8:11], s32 offen offset:1024 nt
    buffer_load_dwordx4 a[104:107], v4, s[8:11], s32 offen offset:2048 nt
    buffer_load_dwordx4 a[108:111], v4, s[8:11], s32 offen offset:3072 nt
    v_mfma_f32_16x16x32_bf16 v[20:23], v[64:67], a[48:51], v[20:23]
    v_mfma_f32_16x16x32_bf16 v[20:23], v[68:71], a[52:55], v[20:23]
    v_mfma_f32_16x16x32_bf16 v[20:23], v[72:75], a[56:59], v[20:23]
    v_mfma_f32_16x16x32_bf16 v[20:23], v[76:79], a[60:63], v[20:23]
    s_waitcnt vmcnt(8)
    buffer_load_dwordx4 a[112:115], v5, s[8:11], s32 offen offset:0 nt
    buffer_load_dwordx4 a[116:119], v5, s[8:11], s32 offen offset:1024 nt
    buffer_load_dwordx4 a[120:123], v5, s[8:11], s32 offen offset:2048 nt
    buffer_load_dwordx4 a[124:127], v5, s[8:11], s32 offen offset:3072 nt
    s_mov_b32 s33, 8
    s_branch L_loop
.p2align 12
L_loop:
    s_cmp_eq_u32 s33, 56
    s_cbranch_scc0 L_it58
    v_add_u32 v97, 16384, v97
    v_min_u32 v97, L_codeend-sequential_preLN__gqa_block_cached__glu_gated_swiglu__decode_kernel-4, v97
    global_load_dword v255, v97, s[46:47]
    global_load_dword v255, v254, s[46:47]
L_it58:
    s_waitcnt vmcnt(8)
    s_cmp_lt_u32 s33, 58
    s_cbranch_scc1 L_ts59
    v_readfirstlane_b32 s48, v98
    s_cmp_ge_u32 s48, 96
    s_cbranch_scc1 L_drain0
    s_lshl_b32 s48, s48, 13
    s_add_u32 s32, s51, s48
    s_branch L_tn60
L_ts59:
    s_add_u32 s32, s32, 131072
L_tn60:
    s_add_u32 s33, s33, 1
    buffer_load_dwordx4 a[0:3], v2, s[4:7], s32 offen offset:0 nt
    buffer_load_dwordx4 a[4:7], v2, s[4:7], s32 offen offset:1024 nt
    buffer_load_dwordx4 a[8:11], v2, s[4:7], s32 offen offset:2048 nt
    buffer_load_dwordx4 a[12:15], v2, s[4:7], s32 offen offset:3072 nt
    v_mfma_f32_16x16x32_bf16 v[24:27], a[64:67], v[10:13], 0
    v_mfma_f32_16x16x32_bf16 v[24:27], a[68:71], v[14:17], v[24:27]
    v_mfma_f32_16x16x32_bf16 v[28:31], a[72:75], v[10:13], 0
    v_mfma_f32_16x16x32_bf16 v[28:31], a[76:79], v[14:17], v[28:31]
    s_waitcnt vmcnt(9)
    buffer_load_dwordx4 a[16:19], v3, s[4:7], s32 offen offset:0 nt
    buffer_load_dwordx4 a[20:23], v3, s[4:7], s32 offen offset:1024 nt
    buffer_load_dwordx4 a[24:27], v3, s[4:7], s32 offen offset:2048 nt
    buffer_load_dwordx4 a[28:31], v3, s[4:7], s32 offen offset:3072 nt
    v_mfma_f32_16x16x32_bf16 v[32:35], a[80:83], v[10:13], 0
    v_mfma_f32_16x16x32_bf16 v[32:35], a[84:87], v[14:17], v[32:35]
    v_mfma_f32_16x16x32_bf16 v[36:39], a[88:91], v[10:13], 0
    v_mfma_f32_16x16x32_bf16 v[36:39], a[92:95], v[14:17], v[36:39]
    v_mov_b32_dpp v40, v24 quad_perm:[0,0,0,0] row_mask:0xf bank_mask:0xf
    v_add_f32_dpp v40, v25, v40 quad_perm:[1,1,1,1] row_mask:0xf bank_mask:0xf
    v_add_f32_dpp v40, v26, v40 quad_perm:[2,2,2,2] row_mask:0xf bank_mask:0xf
    v_add_f32_dpp v40, v27, v40 quad_perm:[3,3,3,3] row_mask:0xf bank_mask:0xf
    v_mov_b32_dpp v41, v28 quad_perm:[0,0,0,0] row_mask:0xf bank_mask:0xf
    v_add_f32_dpp v41, v29, v41 quad_perm:[1,1,1,1] row_mask:0xf bank_mask:0xf
    v_add_f32_dpp v41, v30, v41 quad_perm:[2,2,2,2] row_mask:0xf bank_mask:0xf
    v_add_f32_dpp v41, v31, v41 quad_perm:[3,3,3,3] row_mask:0xf bank_mask:0xf
    v_mov_b32_dpp v42, v32 quad_perm:[0,0,0,0] row_mask:0xf bank_mask:0xf
    v_add_f32_dpp v42, v33, v42 quad_perm:[1,1,1,1] row_mask:0xf bank_mask:0xf
    v_add_f32_dpp v42, v34, v42 quad_perm:[2,2,2,2] row_mask:0xf bank_mask:0xf
    v_add_f32_dpp v42, v35, v42 quad_perm:[3,3,3,3] row_mask:0xf bank_mask:0xf
    v_mov_b32_dpp v43, v36 quad_perm:[0,0,0,0] row_mask:0xf bank_mask:0xf
    v_add_f32_dpp v43, v37, v43 quad_perm:[1,1,1,1] row_mask:0xf bank_mask:0xf
    v_add_f32_dpp v43, v38, v43 quad_perm:[2,2,2,2] row_mask:0xf bank_mask:0xf
    v_add_f32_dpp v43, v39, v43 quad_perm:[3,3,3,3] row_mask:0xf bank_mask:0xf
    v_cndmask_b32 v44, v40, v41, s[40:41]
    v_cndmask_b32 v44, v44, v42, s[42:43]
    v_cndmask_b32 v44, v44, v43, s[44:45]
    v_cvt_pk_bf16_f32 v44, v44, v44
    v_lshlrev_b32 v44, 16, v44
    v_mul_f32 v44, s38, v44
    v_cvt_pk_bf16_f32 v44, v44, v44
    v_lshlrev_b32 v44, 16, v44
    v_cmp_gt_f32 vcc, v44, v18
    s_cbranch_vccnz L_slow61
L_back62:
    v_sub_f32 v45, v44, v18
    v_mul_f32 v45, s39, v45
    v_exp_f32 v45, v45
    s_nop 0
    v_add_f32 v19, v19, v45
    v_mov_b32_dpp v46, v45 row_shl:4 row_mask:0xf bank_mask:0xf bound_ctrl:0
    v_cvt_pk_bf16_f32 v45, v45, v46
    s_nop 1
    v_mov_b32_dpp v40, v45 row_newbcast:0 row_mask:0xf bank_mask:0xf
    v_mov_b32_dpp v41, v45 row_newbcast:8 row_mask:0xf bank_mask:0xf
    v_mov_b32_dpp v42, v45 row_newbcast:1 row_mask:0xf bank_mask:0xf
    v_mov_b32_dpp v43, v45 row_newbcast:9 row_mask:0xf bank_mask:0xf
    v_perm_b32 v48, v40, v40, v6
    v_perm_b32 v49, v40, v40, v7
    v_perm_b32 v50, v40, v40, v8
    v_perm_b32 v51, v40, v40, v9
    v_perm_b32 v52, v41, v41, v6
    v_perm_b32 v53, v41, v41, v7
    v_perm_b32 v54, v41, v41, v8
    v_perm_b32 v55, v41, v41, v9
    v_perm_b32 v56, v42, v42, v6
    v_perm_b32 v57, v42, v42, v7
    v_perm_b32 v58, v42, v42, v8
    v_perm_b32 v59, v42, v42, v9
    v_perm_b32 v60, v43, v43, v6
    v_perm_b32 v61, v43, v43, v7
    v_perm_b32 v62, v43, v43, v8
    v_perm_b32 v63, v43, v43, v9
    v_mov_b32_dpp v40, v45 row_newbcast:2 row_mask:0xf bank_mask:0xf
    v_mov_b32_dpp v41, v45 row_newbcast:10 row_mask:0xf bank_mask:0xf
    v_mov_b32_dpp v42, v45 row_newbcast:3 row_mask:0xf bank_mask:0xf
    v_mov_b32_dpp v43, v45 row_newbcast:11 row_mask:0xf bank_mask:0xf
    v_perm_b32 v64, v40, v40, v6
    v_perm_b32 v65, v40, v40, v7
    v_perm_b32 v66, v40, v40, v8
    v_perm_b32 v67, v40, v40, v9
    v_perm_b32 v68, v41, v41, v6
    v_perm_b32 v69, v41, v41, v7
    v_perm_b32 v70, v41, v41, v8
    v_perm_b32 v71, v41, v41, v9
    v_perm_b32 v72, v42, v42, v6
    v_perm_b32 v73, v42, v42, v7
    v_perm_b32 v74, v42, v42, v8
    v_perm_b32 v75, v42, v42, v9
    v_perm_b32 v76, v43, v43, v6
    v_perm_b32 v77, v43, v43, v7
    v_perm_b32 v78, v43, v43, v8
    v_perm_b32 v79, v43, v43, v9
    s_waitcnt vmcnt(8)
    s_cmp_lt_u32 s33, 58
    s_cbranch_scc1 L_tn63
    v_mov_b32 v98, 1
    s_mov_b64 exec, 1
    buffer_atomic_add v98, v99, s[12:15], 0 offen sc0
    s_mov_b64 exec, -1
L_tn63:
    buffer_load_dwordx4 a[32:35], v4, s[8:11], s32 offen offset:0 nt
    buffer_load_dwordx4 a[36:39], v4, s[8:11], s32 offen offset:1024 nt
    buffer_load_dwordx4 a[40:43], v4, s[8:11], s32 offen offset:2048 nt
    buffer_load_dwordx4 a[44:47], v4, s[8:11], s32 offen offset:3072 nt
    v_mfma_f32_16x16x32_bf16 v[20:23], v[48:51], a[96:99], v[20:23]
    v_mfma_f32_16x16x32_bf16 v[20:23], v[52:55], a[100:103], v[20:23]
    v_mfma_f32_16x16x32_bf16 v[20:23], v[56:59], a[104:107], v[20:23]
    v_mfma_f32_16x16x32_bf16 v[20:23], v[60:63], a[108:111], v[20:23]
    s_waitcnt vmcnt(9)
    buffer_load_dwordx4 a[48:51], v5, s[8:11], s32 offen offset:0 nt
    buffer_load_dwordx4 a[52:55], v5, s[8:11], s32 offen offset:1024 nt
    buffer_load_dwordx4 a[56:59], v5, s[8:11], s32 offen offset:2048 nt
    buffer_load_dwordx4 a[60:63], v5, s[8:11], s32 offen offset:3072 nt
    v_mfma_f32_16x16x32_bf16 v[20:23], v[64:67], a[112:115], v[20:23]
    v_mfma_f32_16x16x32_bf16 v[20:23], v[68:71], a[116:119], v[20:23]
    v_mfma_f32_16x16x32_bf16 v[20:23], v[72:75], a[120:123], v[20:23]
    v_mfma_f32_16x16x32_bf16 v[20:23], v[76:79], a[124:127], v[20:23]
    s_waitcnt vmcnt(8)
    s_cmp_lt_u32 s33, 58
    s_cbranch_scc1 L_ts64
    v_readfirstlane_b32 s48, v98
    s_cmp_ge_u32 s48, 96
    s_cbranch_scc1 L_drain1
    s_lshl_b32 s48, s48, 13
    s_add_u32 s32, s51, s48
    s_branch L_tn65
L_ts64:
    s_add_u32 s32, s32, 131072
L_tn65:
    s_add_u32 s33, s33, 1
    buffer_load_dwordx4 a[64:67], v2, s[4:7], s32 offen offset:0 nt
    buffer_load_dwordx4 a[68:71], v2, s[4:7], s32 offen offset:1024 nt
    buffer_load_dwordx4 a[72:75], v2, s[4:7], s32 offen offset:2048 nt
    buffer_load_dwordx4 a[76:79], v2, s[4:7], s32 offen offset:3072 nt
    v_mfma_f32_16x16x32_bf16 v[24:27], a[0:3], v[10:13], 0
    v_mfma_f32_16x16x32_bf16 v[24:27], a[4:7], v[14:17], v[24:27]
    v_mfma_f32_16x16x32_bf16 v[28:31], a[8:11], v[10:13], 0
    v_mfma_f32_16x16x32_bf16 v[28:31], a[12:15], v[14:17], v[28:31]
    s_waitcnt vmcnt(9)
    buffer_load_dwordx4 a[80:83], v3, s[4:7], s32 offen offset:0 nt
    buffer_load_dwordx4 a[84:87], v3, s[4:7], s32 offen offset:1024 nt
    buffer_load_dwordx4 a[88:91], v3, s[4:7], s32 offen offset:2048 nt
    buffer_load_dwordx4 a[92:95], v3, s[4:7], s32 offen offset:3072 nt
    v_mfma_f32_16x16x32_bf16 v[32:35], a[16:19], v[10:13], 0
    v_mfma_f32_16x16x32_bf16 v[32:35], a[20:23], v[14:17], v[32:35]
    v_mfma_f32_16x16x32_bf16 v[36:39], a[24:27], v[10:13], 0
    v_mfma_f32_16x16x32_bf16 v[36:39], a[28:31], v[14:17], v[36:39]
    v_mov_b32_dpp v40, v24 quad_perm:[0,0,0,0] row_mask:0xf bank_mask:0xf
    v_add_f32_dpp v40, v25, v40 quad_perm:[1,1,1,1] row_mask:0xf bank_mask:0xf
    v_add_f32_dpp v40, v26, v40 quad_perm:[2,2,2,2] row_mask:0xf bank_mask:0xf
    v_add_f32_dpp v40, v27, v40 quad_perm:[3,3,3,3] row_mask:0xf bank_mask:0xf
    v_mov_b32_dpp v41, v28 quad_perm:[0,0,0,0] row_mask:0xf bank_mask:0xf
    v_add_f32_dpp v41, v29, v41 quad_perm:[1,1,1,1] row_mask:0xf bank_mask:0xf
    v_add_f32_dpp v41, v30, v41 quad_perm:[2,2,2,2] row_mask:0xf bank_mask:0xf
    v_add_f32_dpp v41, v31, v41 quad_perm:[3,3,3,3] row_mask:0xf bank_mask:0xf
    v_mov_b32_dpp v42, v32 quad_perm:[0,0,0,0] row_mask:0xf bank_mask:0xf
    v_add_f32_dpp v42, v33, v42 quad_perm:[1,1,1,1] row_mask:0xf bank_mask:0xf
    v_add_f32_dpp v42, v34, v42 quad_perm:[2,2,2,2] row_mask:0xf bank_mask:0xf
    v_add_f32_dpp v42, v35, v42 quad_perm:[3,3,3,3] row_mask:0xf bank_mask:0xf
    v_mov_b32_dpp v43, v36 quad_perm:[0,0,0,0] row_mask:0xf bank_mask:0xf
    v_add_f32_dpp v43, v37, v43 quad_perm:[1,1,1,1] row_mask:0xf bank_mask:0xf
    v_add_f32_dpp v43, v38, v43 quad_perm:[2,2,2,2] row_mask:0xf bank_mask:0xf
    v_add_f32_dpp v43, v39, v43 quad_perm:[3,3,3,3] row_mask:0xf bank_mask:0xf
    v_cndmask_b32 v44, v40, v41, s[40:41]
    v_cndmask_b32 v44, v44, v42, s[42:43]
    v_cndmask_b32 v44, v44, v43, s[44:45]
    v_cvt_pk_bf16_f32 v44, v44, v44
    v_lshlrev_b32 v44, 16, v44
    v_mul_f32 v44, s38, v44
    v_cvt_pk_bf16_f32 v44, v44, v44
    v_lshlrev_b32 v44, 16, v44
    v_cmp_gt_f32 vcc, v44, v18
    s_cbranch_vccnz L_slow66
L_back67:
    v_sub_f32 v45, v44, v18
    v_mul_f32 v45, s39, v45
    v_exp_f32 v45, v45
    s_nop 0
    v_add_f32 v19, v19, v45
    v_mov_b32_dpp v46, v45 row_shl:4 row_mask:0xf bank_mask:0xf bound_ctrl:0
    v_cvt_pk_bf16_f32 v45, v45, v46
    s_nop 1
    v_mov_b32_dpp v40, v45 row_newbcast:0 row_mask:0xf bank_mask:0xf
    v_mov_b32_dpp v41, v45 row_newbcast:8 row_mask:0xf bank_mask:0xf
    v_mov_b32_dpp v42, v45 row_newbcast:1 row_mask:0xf bank_mask:0xf
    v_mov_b32_dpp v43, v45 row_newbcast:9 row_mask:0xf bank_mask:0xf
    v_perm_b32 v48, v40, v40, v6
    v_perm_b32 v49, v40, v40, v7
    v_perm_b32 v50, v40, v40, v8
    v_perm_b32 v51, v40, v40, v9
    v_perm_b32 v52, v41, v41, v6
    v_perm_b32 v53, v41, v41, v7
    v_perm_b32 v54, v41, v41, v8
    v_perm_b32 v55, v41, v41, v9
    v_perm_b32 v56, v42, v42, v6
    v_perm_b32 v57, v42, v42, v7
    v_perm_b32 v58, v42, v42, v8
    v_perm_b32 v59, v42, v42, v9
    v_perm_b32 v60, v43, v43, v6
    v_perm_b32 v61, v43, v43, v7
    v_perm_b32 v62, v43, v43, v8
    v_perm_b32 v63, v43, v43, v9
    v_mov_b32_dpp v40, v45 row_newbcast:2 row_mask:0xf bank_mask:0xf
    v_mov_b32_dpp v41, v45 row_newbcast:10 row_mask:0xf bank_mask:0xf
    v_mov_b32_dpp v42, v45 row_newbcast:3 row_mask:0xf bank_mask:0xf
    v_mov_b32_dpp v43, v45 row_newbcast:11 row_mask:0xf bank_mask:0xf
    v_perm_b32 v64, v40, v40, v6
    v_perm_b32 v65, v40, v40, v7
    v_perm_b32 v66, v40, v40, v8
    v_perm_b32 v67, v40, v40, v9
    v_perm_b32 v68, v41, v41, v6
    v_perm_b32 v69, v41, v41, v7
    v_perm_b32 v70, v41, v41, v8
    v_perm_b32 v71, v41, v41, v9
    v_perm_b32 v72, v42, v42, v6
    v_perm_b32 v73, v42, v42, v7
    v_perm_b32 v74, v42, v42, v8
    v_perm_b32 v75, v42, v42, v9
    v_perm_b32 v76, v43, v43, v6
    v_perm_b32 v77, v43, v43, v7
    v_perm_b32 v78, v43, v43, v8
    v_perm_b32 v79, v43, v43, v9
    s_waitcnt vmcnt(8)
    s_cmp_lt_u32 s33, 58
    s_cbranch_scc1 L_tn68
    v_mov_b32 v98, 1
    s_mov_b64 exec, 1
    buffer_atomic_add v98, v99, s[12:15], 0 offen sc0
    s_mov_b64 exec, -1
L_tn68:
    buffer_load_dwordx4 a[96:99], v4, s[8:11], s32 offen offset:0 nt
    buffer_load_dwordx4 a[100:103], v4, s[8:11], s32 offen offset:1024 nt
    buffer_load_dwordx4 a[104:107], v4, s[8:11], s32 offen offset:2048 nt
    buffer_load_dwordx4 a[108:111], v4, s[8:11], s32 offen offset:3072 nt
    v_mfma_f32_16x16x32_bf16 v[20:23], v[48:51], a[32:35], v[20:23]
    v_mfma_f32_16x16x32_bf16 v[20:23], v[52:55], a[36:39], v[20:23]
    v_mfma_f32_16x16x32_bf16 v[20:23], v[56:59], a[40:43], v[20:23]
    v_mfma_f32_16x16x32_bf16 v[20:23], v[60:63], a[44:47], v[20:23]
    s_waitcnt vmcnt(9)
    buffer_load_dwordx4 a[112:115], v5, s[8:11], s32 offen offset:0 nt
    buffer_load_dwordx4 a[116:119], v5, s[8:11], s32 offen offset:1024 nt
    buffer_load_dwordx4 a[120:123], v5, s[8:11], s32 offen offset:2048 nt
    buffer_load_dwordx4 a[124:127], v5, s[8:11], s32 offen offset:3072 nt
    v_mfma_f32_16x16x32_bf16 v[20:23], v[64:67], a[48:51], v[20:23]
    v_mfma_f32_16x16x32_bf16 v[20:23], v[68:71], a[52:55], v[20:23]
    v_mfma_f32_16x16x32_bf16 v[20:23], v[72:75], a[56:59], v[20:23]
    v_mfma_f32_16x16x32_bf16 v[20:23], v[76:79], a[60:63], v[20:23]
    s_branch L_loop
L_drain0:
    v_mfma_f32_16x16x32_bf16 v[24:27], a[64:67], v[10:13], 0
    v_mfma_f32_16x16x32_bf16 v[24:27], a[68:71], v[14:17], v[24:27]
    v_mfma_f32_16x16x32_bf16 v[28:31], a[72:75], v[10:13], 0
    v_mfma_f32_16x16x32_bf16 v[28:31], a[76:79], v[14:17], v[28:31]
    v_mfma_f32_16x16x32_bf16 v[32:35], a[80:83], v[10:13], 0
    v_mfma_f32_16x16x32_bf16 v[32:35], a[84:87], v[14:17], v[32:35]
    v_mfma_f32_16x16x32_bf16 v[36:39], a[88:91], v[10:13], 0
    v_mfma_f32_16x16x32_bf16 v[36:39], a[92:95], v[14:17], v[36:39]
    s_nop 1
    v_mov_b32_dpp v40, v24 quad_perm:[0,0,0,0] row_mask:0xf bank_mask:0xf
    v_add_f32_dpp v40, v25, v40 quad_perm:[1,1,1,1] row_mask:0xf bank_mask:0xf
    v_add_f32_dpp v40, v26, v40 quad_perm:[2,2,2,2] row_mask:0xf bank_mask:0xf
    v_add_f32_dpp v40, v27, v40 quad_perm:[3,3,3,3] row_mask:0xf bank_mask:0xf
    v_mov_b32_dpp v41, v28 quad_perm:[0,0,0,0] row_mask:0xf bank_mask:0xf
    v_add_f32_dpp v41, v29, v41 quad_perm:[1,1,1,1] row_mask:0xf bank_mask:0xf
    v_add_f32_dpp v41, v30, v41 quad_perm:[2,2,2,2] row_mask:0xf bank_mask:0xf
    v_add_f32_dpp v41, v31, v41 quad_perm:[3,3,3,3] row_mask:0xf bank_mask:0xf
    v_mov_b32_dpp v42, v32 quad_perm:[0,0,0,0] row_mask:0xf bank_mask:0xf
    v_add_f32_dpp v42, v33, v42 quad_perm:[1,1,1,1] row_mask:0xf bank_mask:0xf
    v_add_f32_dpp v42, v34, v42 quad_perm:[2,2,2,2] row_mask:0xf bank_mask:0xf
    v_add_f32_dpp v42, v35, v42 quad_perm:[3,3,3,3] row_mask:0xf bank_mask:0xf
    v_mov_b32_dpp v43, v36 quad_perm:[0,0,0,0] row_mask:0xf bank_mask:0xf
    v_add_f32_dpp v43, v37, v43 quad_perm:[1,1,1,1] row_mask:0xf bank_mask:0xf
    v_add_f32_dpp v43, v38, v43 quad_perm:[2,2,2,2] row_mask:0xf bank_mask:0xf
    v_add_f32_dpp v43, v39, v43 quad_perm:[3,3,3,3] row_mask:0xf bank_mask:0xf
    v_cndmask_b32 v44, v40, v41, s[40:41]
    v_cndmask_b32 v44, v44, v42, s[42:43]
    v_cndmask_b32 v44, v44, v43, s[44:45]
    v_cvt_pk_bf16_f32 v44, v44, v44
    v_lshlrev_b32 v44, 16, v44
    v_mul_f32 v44, s38, v44
    v_cvt_pk_bf16_f32 v44, v44, v44
    v_lshlrev_b32 v44, 16, v44
    v_cmp_gt_f32 vcc, v44, v18
    s_cbranch_vccnz L_slow69
L_back70:
    v_sub_f32 v45, v44, v18
    v_mul_f32 v45, s39, v45
    v_exp_f32 v45, v45
    s_nop 0
    v_add_f32 v19, v19, v45
    s_nop 1
    v_add_f32_dpp v19, v19, v19 quad_perm:[1,0,3,2] row_mask:0xf bank_mask:0xf
    s_nop 1
    v_add_f32_dpp v19, v19, v19 quad_perm:[2,3,0,1] row_mask:0xf bank_mask:0xf
    s_nop 1
    v_add_f32_dpp v19, v19, v19 row_ror:8 row_mask:0xf bank_mask:0xf
    v_mov_b32 v128, v19
    s_nop 1
    v_permlane16_swap_b32 v19, v128
    v_add_f32 v19, v19, v128
    v_mov_b32 v128, v19
    s_nop 1
    v_permlane32_swap_b32 v19, v128
    v_add_f32 v19, v19, v128
    s_mov_b64 exec, 0x11
    ds_write_b64 v94, v[18:19]
    s_mov_b64 exec, -1
    s_waitcnt lgkmcnt(0)
    s_barrier
    ds_read_b64 v[128:129], v95 offset:0
    ds_read_b64 v[130:131], v95 offset:16
    v_mov_b32_dpp v46, v45 row_shl:4 row_mask:0xf bank_mask:0xf bound_ctrl:0
    v_cvt_pk_bf16_f32 v45, v45, v46
    s_nop 1
    v_mov_b32_dpp v40, v45 row_newbcast:0 row_mask:0xf bank_mask:0xf
    v_mov_b32_dpp v41, v45 row_newbcast:8 row_mask:0xf bank_mask:0xf
    v_mov_b32_dpp v42, v45 row_newbcast:1 row_mask:0xf bank_mask:0xf
    v_mov_b32_dpp v43, v45 row_newbcast:9 row_mask:0xf bank_mask:0xf
    v_perm_b32 v48, v40, v40, v6
    v_perm_b32 v49, v40, v40, v7
    v_perm_b32 v50, v40, v40, v8
    v_perm_b32 v51, v40, v40, v9
    v_perm_b32 v52, v41, v41, v6
    v_perm_b32 v53, v41, v41, v7
    v_perm_b32 v54, v41, v41, v8
    v_perm_b32 v55, v41, v41, v9
    v_perm_b32 v56, v42, v42, v6
    v_perm_b32 v57, v42, v42, v7
    v_perm_b32 v58, v42, v42, v8
    v_perm_b32 v59, v42, v42, v9
    v_perm_b32 v60, v43, v43, v6
    v_perm_b32 v61, v43, v43, v7
    v_perm_b32 v62, v43, v43, v8
    v_perm_b32 v63, v43, v43, v9
    s_cmp_eq_u32 s3, 0
    s_cselect_b64 vcc, -1, 0
    s_waitcnt vmcnt(4) lgkmcnt(0)
    v_mfma_f32_16x16x32_bf16 v[20:23], v[48:51], a[96:99], v[20:23]
    v_mfma_f32_16x16x32_bf16 v[20:23], v[52:55], a[100:103], v[20:23]
    v_mfma_f32_16x16x32_bf16 v[20:23], v[56:59], a[104:107], v[20:23]
    v_mfma_f32_16x16x32_bf16 v[20:23], v[60:63], a[108:111], v[20:23]
    v_mov_b32_dpp v40, v45 row_newbcast:2 row_mask:0xf bank_mask:0xf
    v_mov_b32_dpp v41, v45 row_newbcast:10 row_mask:0xf bank_mask:0xf
    v_mov_b32_dpp v42, v45 row_newbcast:3 row_mask:0xf bank_mask:0xf
    v_mov_b32_dpp v43, v45 row_newbcast:11 row_mask:0xf bank_mask:0xf
    v_perm_b32 v64, v40, v40, v6
    v_perm_b32 v65, v40, v40, v7
    v_perm_b32 v66, v40, v40, v8
    v_perm_b32 v67, v40, v40, v9
    v_perm_b32 v68, v41, v41, v6
    v_perm_b32 v69, v41, v41, v7
    v_perm_b32 v70, v41, v41, v8
    v_perm_b32 v71, v41, v41, v9
    v_perm_b32 v72, v42, v42, v6
    v_perm_b32 v73, v42, v42, v7
    v_perm_b32 v74, v42, v42, v8
    v_perm_b32 v75, v42, v42, v9
    v_perm_b32 v76, v43, v43, v6
    v_perm_b32 v77, v43, v43, v7
    v_perm_b32 v78, v43, v43, v8
    v_perm_b32 v79, v43, v43, v9
    s_waitcnt vmcnt(0)
    v_mfma_f32_16x16x32_bf16 v[20:23], v[64:67], a[112:115], v[20:23]
    v_max_f32 v138, v128, v130
    v_sub_f32 v128, v128, v138
    v_sub_f32 v130, v130, v138
    v_mfma_f32_16x16x32_bf16 v[20:23], v[68:71], a[116:119], v[20:23]
    v_mul_f32 v128, s39, v128
    v_mul_f32 v130, s39, v130
    v_exp_f32 v128, v128
    v_mfma_f32_16x16x32_bf16 v[20:23], v[72:75], a[120:123], v[20:23]
    v_exp_f32 v130, v130
    v_mul_f32 v139, v128, v129
    v_fmac_f32 v139, v130, v131
    v_mfma_f32_16x16x32_bf16 v[20:23], v[76:79], a[124:127], v[20:23]
    v_rcp_f32 v136, v139
    v_cndmask_b32 v128, v130, v128, vcc
    v_mul_f32 v136, v136, v128
    s_branch L_join
L_drain1:
    v_mfma_f32_16x16x32_bf16 v[24:27], a[0:3], v[10:13], 0
    v_mfma_f32_16x16x32_bf16 v[24:27], a[4:7], v[14:17], v[24:27]
    v_mfma_f32_16x16x32_bf16 v[28:31], a[8:11], v[10:13], 0
    v_mfma_f32_16x16x32_bf16 v[28:31], a[12:15], v[14:17], v[28:31]
    v_mfma_f32_16x16x32_bf16 v[32:35], a[16:19], v[10:13], 0
    v_mfma_f32_16x16x32_bf16 v[32:35], a[20:23], v[14:17], v[32:35]
    v_mfma_f32_16x16x32_bf16 v[36:39], a[24:27], v[10:13], 0
    v_mfma_f32_16x16x32_bf16 v[36:39], a[28:31], v[14:17], v[36:39]
    s_nop 1
    v_mov_b32_dpp v40, v24 quad_perm:[0,0,0,0] row_mask:0xf bank_mask:0xf
    v_add_f32_dpp v40, v25, v40 quad_perm:[1,1,1,1] row_mask:0xf bank_mask:0xf
    v_add_f32_dpp v40, v26, v40 quad_perm:[2,2,2,2] row_mask:0xf bank_mask:0xf
    v_add_f32_dpp v40, v27, v40 quad_perm:[3,3,3,3] row_mask:0xf bank_mask:0xf
    v_mov_b32_dpp v41, v28 quad_perm:[0,0,0,0] row_mask:0xf bank_mask:0xf
    v_add_f32_dpp v41, v29, v41 quad_perm:[1,1,1,1] row_mask:0xf bank_mask:0xf
    v_add_f32_dpp v41, v30, v41 quad_perm:[2,2,2,2] row_mask:0xf bank_mask:0xf
    v_add_f32_dpp v41, v31, v41 quad_perm:[3,3,3,3] row_mask:0xf bank_mask:0xf
    v_mov_b32_dpp v42, v32 quad_perm:[0,0,0,0] row_mask:0xf bank_mask:0xf
    v_add_f32_dpp v42, v33, v42 quad_perm:[1,1,1,1] row_mask:0xf bank_mask:0xf
    v_add_f32_dpp v42, v34, v42 quad_perm:[2,2,2,2] row_mask:0xf bank_mask:0xf
    v_add_f32_dpp v42, v35, v42 quad_perm:[3,3,3,3] row_mask:0xf bank_mask:0xf
    v_mov_b32_dpp v43, v36 quad_perm:[0,0,0,0] row_mask:0xf bank_mask:0xf
    v_add_f32_dpp v43, v37, v43 quad_perm:[1,1,1,1] row_mask:0xf bank_mask:0xf
    v_add_f32_dpp v43, v38, v43 quad_perm:[2,2,2,2] row_mask:0xf bank_mask:0xf
    v_add_f32_dpp v43, v39, v43 quad_perm:[3,3,3,3] row_mask:0xf bank_mask:0xf
    v_cndmask_b32 v44, v40, v41, s[40:41]
    v_cndmask_b32 v44, v44, v42, s[42:43]
    v_cndmask_b32 v44, v44, v43, s[44:45]
    v_cvt_pk_bf16_f32 v44, v44, v44
    v_lshlrev_b32 v44, 16, v44
    v_mul_f32 v44, s38, v44
    v_cvt_pk_bf16_f32 v44, v44, v44
    v_lshlrev_b32 v44, 16, v44
    v_cmp_gt_f32 vcc, v44, v18
    s_cbranch_vccnz L_slow71
L_back72:
    v_sub_f32 v45, v44, v18
    v_mul_f32 v45, s39, v45
    v_exp_f32 v45, v45
    s_nop 0
    v_add_f32 v19, v19, v45
    s_nop 1
    v_add_f32_dpp v19, v19, v19 quad_perm:[1,0,3,2] row_mask:0xf bank_mask:0xf
    s_nop 1
    v_add_f32_dpp v19, v19, v19 quad_perm:[2,3,0,1] row_mask:0xf bank_mask:0xf
    s_nop 1
    v_add_f32_dpp v19, v19, v19 row_ror:8 row_mask:0xf bank_mask:0xf
    v_mov_b32 v128, v19
    s_nop 1
    v_permlane16_swap_b32 v19, v128
    v_add_f32 v19, v19, v128
    v_mov_b32 v128, v19
    s_nop 1
    v_permlane32_swap_b32 v19, v128
    v_add_f32 v19, v19, v128
    s_mov_b64 exec, 0x11
    ds_write_b64 v94, v[18:19]
    s_mov_b64 exec, -1
    s_waitcnt lgkmcnt(0)
    s_barrier
    ds_read_b64 v[128:129], v95 offset:0
    ds_read_b64 v[130:131], v95 offset:16
    v_mov_b32_dpp v46, v45 row_shl:4 row_mask:0xf bank_mask:0xf bound_ctrl:0
    v_cvt_pk_bf16_f32 v45, v45, v46
    s_nop 1
    v_mov_b32_dpp v40, v45 row_newbcast:0 row_mask:0xf bank_mask:0xf
    v_mov_b32_dpp v41, v45 row_newbcast:8 row_mask:0xf bank_mask:0xf
    v_mov_b32_dpp v42, v45 row_newbcast:1 row_mask:0xf bank_mask:0xf
    v_mov_b32_dpp v43, v45 row_newbcast:9 row_mask:0xf bank_mask:0xf
    v_perm_b32 v48, v40, v40, v6
    v_perm_b32 v49, v40, v40, v7
    v_perm_b32 v50, v40, v40, v8
    v_perm_b32 v51, v40, v40, v9
    v_perm_b32 v52, v41, v41, v6
    v_perm_b32 v53, v41, v41, v7
    v_perm_b32 v54, v41, v41, v8
    v_perm_b32 v55, v41, v41, v9
    v_perm_b32 v56, v42, v42, v6
    v_perm_b32 v57, v42, v42, v7
    v_perm_b32 v58, v42, v42, v8
    v_perm_b32 v59, v42, v42, v9
    v_perm_b32 v60, v43, v43, v6
    v_perm_b32 v61, v43, v43, v7
    v_perm_b32 v62, v43, v43, v8
    v_perm_b32 v63, v43, v43, v9
    s_cmp_eq_u32 s3, 0
    s_cselect_b64 vcc, -1, 0
    s_waitcnt vmcnt(4) lgkmcnt(0)
    v_mfma_f32_16x16x32_bf16 v[20:23], v[48:51], a[32:35], v[20:23]
    v_mfma_f32_16x16x32_bf16 v[20:23], v[52:55], a[36:39], v[20:23]
    v_mfma_f32_16x16x32_bf16 v[20:23], v[56:59], a[40:43], v[20:23]
    v_mfma_f32_16x16x32_bf16 v[20:23], v[60:63], a[44:47], v[20:23]
    v_mov_b32_dpp v40, v45 row_newbcast:2 row_mask:0xf bank_mask:0xf
    v_mov_b32_dpp v41, v45 row_newbcast:10 row_mask:0xf bank_mask:0xf
    v_mov_b32_dpp v42, v45 row_newbcast:3 row_mask:0xf bank_mask:0xf
    v_mov_b32_dpp v43, v45 row_newbcast:11 row_mask:0xf bank_mask:0xf
    v_perm_b32 v64, v40, v40, v6
    v_perm_b32 v65, v40, v40, v7
    v_perm_b32 v66, v40, v40, v8
    v_perm_b32 v67, v40, v40, v9
    v_perm_b32 v68, v41, v41, v6
    v_perm_b32 v69, v41, v41, v7
    v_perm_b32 v70, v41, v41, v8
    v_perm_b32 v71, v41, v41, v9
    v_perm_b32 v72, v42, v42, v6
    v_perm_b32 v73, v42, v42, v7
    v_perm_b32 v74, v42, v42, v8
    v_perm_b32 v75, v42, v42, v9
    v_perm_b32 v76, v43, v43, v6
    v_perm_b32 v77, v43, v43, v7
    v_perm_b32 v78, v43, v43, v8
    v_perm_b32 v79, v43, v43, v9
    s_waitcnt vmcnt(0)
    v_mfma_f32_16x16x32_bf16 v[20:23], v[64:67], a[48:51], v[20:23]
    v_max_f32 v138, v128, v130
    v_sub_f32 v128, v128, v138
    v_sub_f32 v130, v130, v138
    v_mfma_f32_16x16x32_bf16 v[20:23], v[68:71], a[52:55], v[20:23]
    v_mul_f32 v128, s39, v128
    v_mul_f32 v130, s39, v130
    v_exp_f32 v128, v128
    v_mfma_f32_16x16x32_bf16 v[20:23], v[72:75], a[56:59], v[20:23]
    v_exp_f32 v130, v130
    v_mul_f32 v139, v128, v129
    v_fmac_f32 v139, v130, v131
    v_mfma_f32_16x16x32_bf16 v[20:23], v[76:79], a[60:63], v[20:23]
    v_rcp_f32 v136, v139
    v_cndmask_b32 v128, v130, v128, vcc
    v_mul_f32 v136, v136, v128
L_join:
    s_nop 4
    v_mul_f32 v20, v20, v136
    v_mul_f32 v21, v21, v136
    v_mul_f32 v22, v22, v136
    v_mul_f32 v23, v23, v136
    ds_write_b128 v92, v[20:23]
    s_waitcnt lgkmcnt(0)
    s_barrier
L_tail:
    s_cmp_eq_u32 s35, 1
    s_cbranch_scc1 L_ffn
    s_cmp_eq_u32 s35, 0
    s_cbranch_scc0 L_fin
    s_branch L_t2
.p2align 12
L_hlate:
    s_lshl_b32 s60, s59, 16
    s_add_u32 s60, s60, 1048580
    v_lshl_add_u32 v128, v1, 10, s60
    s_mov_b32 s50, 65536
L_ev73:
    buffer_load_dword v133, v128, s[12:15], 0 offen sc1
    buffer_load_dword v135, v128, s[12:15], 0 offen offset:512 sc1
    s_waitcnt vmcnt(0)
    v_xor_b32 v133, s34, v133
    v_xor_b32 v135, s34, v135
    v_or_b32 v133, v133, v135
    v_cmp_ne_u32 vcc, 0, v133
    s_cbranch_vccz L_evok74
    s_sub_u32 s50, s50, 1
    s_cbranch_scc0 L_ev73
L_evok74:
    s_barrier
    ds_read_b64 v[128:129], v95 offset:0
    ds_read_b64 v[130:131], v95 offset:16
    s_waitcnt lgkmcnt(0)
    v_max_f32 v138, v128, v130
    v_sub_f32 v128, v128, v138
    v_sub_f32 v130, v130, v138
    v_mul_f32 v128, s39, v128
    v_mul_f32 v130, s39, v130
    v_exp_f32 v128, v128
    v_exp_f32 v130, v130
    v_mul_f32 v139, v128, v129
    v_fmac_f32 v139, v130, v131
    s_lshl_b32 s60, s59, 5
    s_lshl_b64 exec, 1, s60
    buffer_store_dwordx2 v[138:139], v86, s[12:15], 0 offen sc1
    s_mov_b64 exec, -1
    s_barrier
    ds_read_b64 v[128:129], v93 offset:0
    ds_read_b64 v[130:131], v93 offset:1024
    s_waitcnt lgkmcnt(0)
    v_pk_add_f32 v[128:129], v[128:129], v[130:131]
    v_cvt_pk_bf16_f32 v128, v128, v129
    buffer_store_dword v128, v85, s[12:15], 0 offen sc1
    s_cmp_eq_u32 s35, 0
    s_cbranch_scc0 L_hf75
    s_branch L_tail
L_hf75:
    s_cmp_eq_u32 s35, 1
    s_cbranch_scc0 L_tail
    s_mov_b32 m0, s76
    s_nop 0
    buffer_load_dwordx4 v202, s[24:27], s79 offen nt lds
    s_add_u32 s76, s76, 1024
    s_mov_b32 m0, s76
    s_nop 0
    buffer_load_dwordx4 v203, s[24:27], s79 offen nt lds
    s_add_u32 s76, s76, 1024
    s_mov_b32 m0, s76
    s_nop 0
    buffer_load_dwordx4 v204, s[24:27], s79 offen nt lds
    s_add_u32 s76, s76, 1024
    s_mov_b32 m0, s76
    s_nop 0
    buffer_load_dwordx4 v205, s[24:27], s79 offen nt lds
    s_add_u32 s76, s76, 1024
    s_mov_b32 m0, s76
    s_nop 0
    buffer_load_dwordx4 v206, s[24:27], s79 offen nt lds
    s_add_u32 s76, s76, 1024
    s_mov_b32 m0, s76
    s_nop 0
    buffer_load_dwordx4 v207, s[24:27], s79 offen nt lds
    s_add_u32 s76, s76, 1024
    s_mov_b32 m0, s76
    s_nop 0
    buffer_load_dwordx4 v208, s[24:27], s79 offen nt lds
    s_add_u32 s76, s76, 1024
    s_mov_b32 m0, s76
    s_nop 0
    buffer_load_dwordx4 v209, s[24:27], s79 offen nt lds
    s_add_u32 s76, s76, 1024
    s_mov_b32 m0, s76
    s_nop 0
    buffer_load_dwordx4 v210, s[24:27], s79 offen nt lds
    s_add_u32 s76, s76, 1024
    s_mov_b32 m0, s76
    s_nop 0
    buffer_load_dwordx4 v211, s[24:27], s79 offen nt lds
    s_add_u32 s76, s76, 1024
    s_mov_b32 m0, s76
    s_nop 0
    buffer_load_dwordx4 v212, s[24:27], s79 offen nt lds
    s_add_u32 s76, s76, 1024
    s_mov_b32 m0, s76
    s_nop 0
    buffer_load_dwordx4 v213, s[24:27], s79 offen nt lds
    s_add_u32 s76, s76, 1024
    s_mov_b32 m0, s76
    s_nop 0
    buffer_load_dwordx4 v214, s[24:27], s79 offen nt lds
    s_add_u32 s76, s76, 1024
    s_mov_b32 m0, s76
    s_nop 0
    buffer_load_dwordx4 v215, s[24:27], s79 offen nt lds
    s_add_u32 s76, s76, 1024
    s_mov_b32 m0, s76
    s_nop 0
    buffer_load_dwordx4 v216, s[24:27], s79 offen nt lds
    s_add_u32 s76, s76, 1024
    s_mov_b32 m0, s76
    s_nop 0
    buffer_load_dwordx4 v217, s[24:27], s79 offen nt lds
    s_add_u32 s76, s76, 1024
    s_mov_b32 m0, s76
    s_nop 0
    buffer_load_dwordx4 v218, s[24:27], s79 offen nt lds
    s_add_u32 s76, s76, 1024
    s_mov_b32 m0, s76
    s_nop 0
    buffer_load_dwordx4 v219, s[24:27], s79 offen nt lds
    s_add_u32 s76, s76, 1024
    s_branch L_tail
L_t2:
    buffer_load_dwordx2 v[188:189], v112, s[16:19], 0 offen
    buffer_load_dwordx2 v[144:145], v105, s[12:15], 0 offen sc1
    ds_read_b64_tr_b16 a[128:129], v103 offset:0
    ds_read_b64_tr_b16 a[130:131], v103 offset:1536
    ds_read_b64_tr_b16 a[132:133], v103 offset:32
    ds_read_b64_tr_b16 a[134:135], v103 offset:1568
    ds_read_b64_tr_b16 a[136:137], v103 offset:64
    ds_read_b64_tr_b16 a[138:139], v103 offset:1600
    ds_read_b64_tr_b16 a[140:141], v103 offset:3072
    ds_read_b64_tr_b16 a[142:143], v103 offset:4608
    ds_read_b64_tr_b16 a[144:145], v103 offset:3104
    ds_read_b64_tr_b16 a[146:147], v103 offset:4640
    ds_read_b64_tr_b16 a[148:149], v103 offset:3136
    ds_read_b64_tr_b16 a[150:151], v103 offset:4672
    ds_read_b64_tr_b16 a[152:153], v103 offset:6144
    ds_read_b64_tr_b16 a[154:155], v103 offset:7680
    ds_read_b64_tr_b16 a[156:157], v103 offset:6176
    ds_read_b64_tr_b16 a[158:159], v103 offset:7712
    ds_read_b64_tr_b16 a[160:161], v103 offset:6208
    ds_read_b64_tr_b16 a[162:163], v103 offset:7744
    ds_read_b64_tr_b16 a[164:165], v103 offset:9216
    ds_read_b64_tr_b16 a[166:167], v103 offset:10752
    ds_read_b64_tr_b16 a[168:169], v103 offset:9248
    ds_read_b64_tr_b16 a[170:171], v103 offset:10784
    ds_read_b64_tr_b16 a[172:173], v103 offset:9280
    ds_read_b64_tr_b16 a[174:175], v103 offset:10816
    s_mov_b32 s50, 65536
L_poll78:
    s_waitcnt vmcnt(0)
    v_max_u32 v146, v144, v145
    v_cmp_eq_u32 vcc, -1, v146
    s_cbranch_vccz L_e0ok770
    s_sub_u32 s50, s50, 1
    s_cbranch_scc1 L_e0ok770
    buffer_load_dwordx2 v[144:145], v105, s[12:15], 0 offen sc1
    s_branch L_poll78
L_e0ok770:
    v_mov_b32 v212, v144
    v_mov_b32 v213, v145
L_e0ok77m:
    s_nop 0
    v_max_f32_dpp v164, v212, v212 quad_perm:[1,0,3,2] row_mask:0xf bank_mask:0xf
    s_nop 1
    v_max_f32_dpp v164, v164, v164 quad_perm:[2,3,0,1] row_mask:0xf bank_mask:0xf
    s_nop 1
    v_max_f32_dpp v164, v164, v164 row_half_mirror row_mask:0xf bank_mask:0xf
    v_sub_f32 v165, v212, v164
    v_mul_f32 v165, s39, v165
    v_exp_f32 v165, v165
    s_nop 0
    v_mul_f32 v165, v165, v213
    s_nop 1
    v_add_f32_dpp v164, v165, v165 quad_perm:[1,0,3,2] row_mask:0xf bank_mask:0xf
    s_nop 1
    v_add_f32_dpp v164, v164, v164 quad_perm:[2,3,0,1] row_mask:0xf bank_mask:0xf
    s_nop 1
    v_add_f32_dpp v164, v164, v164 row_half_mirror row_mask:0xf bank_mask:0xf
    v_rcp_f32 v164, v164
    s_nop 0
    v_mul_f32 v165, v165, v164
    buffer_load_dwordx4 v[128:131], v104, s[12:15], 0 offen offset:0 sc1
    buffer_load_dwordx4 v[132:135], v104, s[12:15], 0 offen offset:64 sc1
    buffer_load_dwordx4 v[136:139], v104, s[12:15], 0 offen offset:128 sc1
    buffer_load_dwordx4 v[140:143], v104, s[12:15], 0 offen offset:192 sc1
    s_mov_b32 s50, 65536
L_e179:
    s_waitcnt vmcnt(0)
L_e1b76:
    v_max3_u32 v146, v128, v129, v130
    v_max3_u32 v147, v131, v132, v133
    v_max3_u32 v148, v134, v135, v136
    v_max3_u32 v149, v137, v138, v139
    v_max3_u32 v150, v140, v141, v142
    v_max3_u32 v151, v143, v143, v143
    v_max3_u32 v146, v146, v147, v148
    v_max3_u32 v149, v149, v150, v151
    v_max_u32 v146, v146, v149
    v_cmp_eq_u32 vcc, -1, v146
    s_cbranch_vccz L_e1ok80
    s_sub_u32 s50, s50, 1
    s_cbranch_scc1 L_e1ok80
    s_mov_b64 exec, vcc
    buffer_load_dwordx4 v[128:131], v104, s[12:15], 0 offen offset:0 sc1
    buffer_load_dwordx4 v[132:135], v104, s[12:15], 0 offen offset:64 sc1
    buffer_load_dwordx4 v[136:139], v104, s[12:15], 0 offen offset:128 sc1
    buffer_load_dwordx4 v[140:143], v104, s[12:15], 0 offen offset:192 sc1
    s_mov_b64 exec, -1
    s_branch L_e179
L_e1ok80:
    v_mov_b32 v166, 119296
    v_mov_b32 v167, 1
    s_waitcnt lgkmcnt(0)
    s_mov_b64 exec, 1
    ds_add_rtn_u32 v167, v166, v167
    s_mov_b64 exec, -1
    v_mfma_f32_16x16x32_bf16 v[152:155], v[128:131], a[128:131], 0
    v_mfma_f32_16x16x32_bf16 v[156:159], v[128:131], a[132:135], 0
    v_mfma_f32_16x16x32_bf16 v[160:163], v[128:131], a[136:139], 0
    s_waitcnt lgkmcnt(0)
    v_readfirstlane_b32 s60, v167
    v_mov_b32 v166, s34
    s_cmp_eq_u32 s60, 3
    s_cbranch_scc0 L_f281
    s_mov_b64 exec, 0xff
    buffer_store_dword v166, v118, s[12:15], 0 offen sc1
    s_mov_b64 exec, -1
L_f281:
    v_mfma_f32_16x16x32_bf16 v[152:155], v[132:135], a[140:143], v[152:155]
    v_mfma_f32_16x16x32_bf16 v[156:159], v[132:135], a[144:147], v[156:159]
    v_mfma_f32_16x16x32_bf16 v[160:163], v[132:135], a[148:151], v[160:163]
    v_mfma_f32_16x16x32_bf16 v[152:155], v[136:139], a[152:155], v[152:155]
    v_mfma_f32_16x16x32_bf16 v[156:159], v[136:139], a[156:159], v[156:159]
    v_mfma_f32_16x16x32_bf16 v[160:163], v[136:139], a[160:163], v[160:163]
    v_mfma_f32_16x16x32_bf16 v[152:155], v[140:143], a[164:167], v[152:155]
    v_mfma_f32_16x16x32_bf16 v[156:159], v[140:143], a[168:171], v[156:159]
    v_mfma_f32_16x16x32_bf16 v[160:163], v[140:143], a[172:175], v[160:163]
    s_nop 5
    v_mul_f32_dpp v168, v165, v152 row_newbcast:0 row_mask:0xf bank_mask:0xf
    v_mul_f32_dpp v169, v165, v156 row_newbcast:0 row_mask:0xf bank_mask:0xf
    v_mul_f32_dpp v170, v165, v160 row_newbcast:0 row_mask:0xf bank_mask:0xf
    v_fmac_f32_dpp v168, v165, v153 row_newbcast:1 row_mask:0xf bank_mask:0xf
    v_fmac_f32_dpp v169, v165, v157 row_newbcast:1 row_mask:0xf bank_mask:0xf
    v_fmac_f32_dpp v170, v165, v161 row_newbcast:1 row_mask:0xf bank_mask:0xf
    v_fmac_f32_dpp v168, v165, v154 row_newbcast:2 row_mask:0xf bank_mask:0xf
    v_fmac_f32_dpp v169, v165, v158 row_newbcast:2 row_mask:0xf bank_mask:0xf
    v_fmac_f32_dpp v170, v165, v162 row_newbcast:2 row_mask:0xf bank_mask:0xf
    v_fmac_f32_dpp v168, v165, v155 row_newbcast:3 row_mask:0xf bank_mask:0xf
    v_fmac_f32_dpp v169, v165, v159 row_newbcast:3 row_mask:0xf bank_mask:0xf
    v_fmac_f32_dpp v170, v165, v163 row_newbcast:3 row_mask:0xf bank_mask:0xf
    v_mov_b32 v171, v170
    v_permlane16_swap_b32 v168, v169
    s_nop 0
    v_permlane16_swap_b32 v170, v171
    v_add_f32 v168, v168, v169
    v_add_f32 v170, v170, v171
    ds_write_b32 v106, v168
    ds_write_b32 v107, v170
    s_waitcnt lgkmcnt(0)
    s_barrier
    s_cmp_eq_u32 s68, 0
    s_cbranch_scc0 L_ap82
    ds_read2_b32 v[168:169], v108 offset0:0 offset1:96
    ds_read_b32 v170, v108 offset:768
    ds_read_b32 v171, v108 offset:1152
    s_mov_b32 exec_hi, 0xffff
    s_waitcnt lgkmcnt(0)
    v_add_f32 v168, v168, v169
    v_add_f32 v170, v170, v171
    v_add_f32 v168, v168, v170
    buffer_store_dword v168, v109, s[12:15], 0 offen sc1
    s_mov_b64 exec, -1
L_ap82:
    s_cmp_lt_u32 s37, 9
    s_cbranch_scc0 L_fin
    v_mov_b32 v200, 0
    v_mov_b32 v201, 0
    v_mov_b32 v202, 0
    v_mov_b32 v203, 0
    s_cmp_eq_u32 s3, 3
    s_cbranch_scc0 L_fw83
    s_lshl_b32 s60, s54, 15
    s_add_u32 s60, s60, 1835008
    v_lshl_add_u32 v172, v1, 7, s60
    v_mov_b32 v210, s34
    s_mov_b32 s60, 8192
    s_mov_b32 s61, 16384
    s_mov_b32 s50, 65536
    buffer_load_dword v208, v172, s[12:15], 0 offen sc1
    buffer_load_dword v209, v172, s[12:15], s60 offen sc1
    s_mov_b64 exec, 0xffff
    buffer_load_dword v210, v172, s[12:15], s61 offen sc1
    s_mov_b64 exec, -1
L_poll86:
    s_waitcnt vmcnt(0)
    v_xor_b32 v173, s34, v208
    v_xor_b32 v174, s34, v209
    v_xor_b32 v175, s34, v210
    v_or3_b32 v173, v173, v174, v175
    v_cmp_ne_u32 vcc, 0, v173
    s_cbranch_vccz L_f3ok85
    s_sub_u32 s50, s50, 1
    s_cbranch_scc1 L_f3ok85
    buffer_load_dword v208, v172, s[12:15], 0 offen sc1
    buffer_load_dword v209, v172, s[12:15], s60 offen sc1
    s_mov_b64 exec, 0xffff
    buffer_load_dword v210, v172, s[12:15], s61 offen sc1
    s_mov_b64 exec, -1
    s_branch L_poll86
L_f3ok85:
    s_branch L_fj84
L_fw83:
    s_cmp_eq_u32 s3, 0
    s_cbranch_scc0 L_fj84
    s_mov_b32 s50, 65536
L_f2c87:
    buffer_load_dword v172, v113, s[12:15], 0 offen sc1
    s_waitcnt vmcnt(0)
    v_cmp_ne_u32 vcc, s34, v172
    s_cbranch_vccz L_f2ok88
    s_sub_u32 s50, s50, 1
    s_cbranch_scc0 L_f2c87
L_f2ok88:
    s_mov_b32 s50, 65536
L_e289:
    buffer_load_dwordx4 v[172:175], v110, s[12:15], 0 offen sc1
    s_waitcnt vmcnt(0)
    v_add_f32_dpp v172, v172, v172 quad_perm:[1,0,3,2] row_mask:0xf bank_mask:0xf
    v_add_f32_dpp v173, v173, v173 quad_perm:[1,0,3,2] row_mask:0xf bank_mask:0xf
    v_add_f32_dpp v174, v174, v174 quad_perm:[1,0,3,2] row_mask:0xf bank_mask:0xf
    v_add_f32_dpp v175, v175, v175 quad_perm:[1,0,3,2] row_mask:0xf bank_mask:0xf
    v_add_f32_dpp v172, v172, v172 quad_perm:[2,3,0,1] row_mask:0xf bank_mask:0xf
    v_add_f32_dpp v173, v173, v173 quad_perm:[2,3,0,1] row_mask:0xf bank_mask:0xf
    v_add_f32_dpp v174, v174, v174 quad_perm:[2,3,0,1] row_mask:0xf bank_mask:0xf
    v_add_f32_dpp v175, v175, v175 quad_perm:[2,3,0,1] row_mask:0xf bank_mask:0xf
    v_add_f32_dpp v172, v172, v172 row_half_mirror row_mask:0xf bank_mask:0xf
    v_add_f32_dpp v173, v173, v173 row_half_mirror row_mask:0xf bank_mask:0xf
    v_add_f32_dpp v174, v174, v174 row_half_mirror row_mask:0xf bank_mask:0xf
    v_add_f32_dpp v175, v175, v175 row_half_mirror row_mask:0xf bank_mask:0xf
    v_add_f32 v176, v172, v173
    v_add_f32 v177, v174, v175
    v_cmp_u_f32 vcc, v176, v177
    s_cbranch_vccz L_e2ok90
    s_sub_u32 s50, s50, 1
    s_cbranch_scc0 L_e289
L_e2ok90:
    v_cvt_pk_bf16_f32 v172, v172, v173
    v_cvt_pk_bf16_f32 v174, v174, v175
    v_lshlrev_b32 v180, 16, v172
    v_and_b32 v181, 0xffff0000, v172
    v_lshlrev_b32 v176, 16, v188
    v_and_b32 v177, 0xffff0000, v188
    v_add_f32 v180, v180, v176
    v_add_f32 v181, v181, v177
    v_cvt_pk_bf16_f32 v176, v180, v181
    v_lshlrev_b32 v180, 16, v176
    v_and_b32 v181, 0xffff0000, v176
    v_lshlrev_b32 v182, 16, v174
    v_and_b32 v183, 0xffff0000, v174
    v_lshlrev_b32 v176, 16, v189
    v_and_b32 v177, 0xffff0000, v189
    v_add_f32 v182, v182, v176
    v_add_f32 v183, v183, v177
    v_cvt_pk_bf16_f32 v176, v182, v183
    v_lshlrev_b32 v182, 16, v176
    v_and_b32 v183, 0xffff0000, v176
    ds_write_b128 v114, v[180:183]
    v_lshlrev_b32 v172, 2, v253
    v_add_u32 v172, 119360, v172
    s_waitcnt lgkmcnt(0)
    ds_read_b32 v180, v172
    s_waitcnt lgkmcnt(0)
L_fj84:
    s_mov_b32 s60, 2048
    s_mov_b32 s61, 4096
    s_mov_b32 s50, 65536
    s_barrier
    s_mov_b64 vcc, -1
L_e391:
    s_mov_b64 exec, vcc
    buffer_load_dwordx4 v[224:227], v111, s[12:15], 0 offen sc1
    buffer_load_dwordx4 v[228:231], v111, s[12:15], s60 offen sc1
    s_mov_b64 exec, 0xffff
    buffer_load_dwordx4 v[200:203], v111, s[12:15], s61 offen sc1
    s_mov_b64 exec, -1
    s_waitcnt vmcnt(1)
    v_pk_add_f32 v[192:193], v[224:225], v[228:229]
    v_pk_add_f32 v[194:195], v[226:227], v[230:231]
    s_waitcnt vmcnt(0)
    v_pk_add_f32 v[192:193], v[192:193], v[200:201]
    v_pk_add_f32 v[194:195], v[194:195], v[202:203]
    v_pk_add_f32 v[196:197], v[192:193], v[194:195]
    v_cmp_u_f32 vcc, v196, v197
    s_cbranch_vccz L_e3ok92
    s_sub_u32 s50, s50, 1
    s_cbranch_scc0 L_e391
L_e3ok92:
    v_add_f32_dpp v192, v192, v192 row_ror:4 row_mask:0xf bank_mask:0xf
    v_add_f32_dpp v193, v193, v193 row_ror:4 row_mask:0xf bank_mask:0xf
    v_add_f32_dpp v194, v194, v194 row_ror:4 row_mask:0xf bank_mask:0xf
    v_add_f32_dpp v195, v195, v195 row_ror:4 row_mask:0xf bank_mask:0xf
    v_add_f32_dpp v192, v192, v192 row_ror:8 row_mask:0xf bank_mask:0xf
    v_add_f32_dpp v193, v193, v193 row_ror:8 row_mask:0xf bank_mask:0xf
    v_add_f32_dpp v194, v194, v194 row_ror:8 row_mask:0xf bank_mask:0xf
    v_add_f32_dpp v195, v195, v195 row_ror:8 row_mask:0xf bank_mask:0xf
    s_mov_b32 exec_lo, 0xf000f
    s_mov_b32 exec_hi, 0xf000f
    ds_write_b128 v115, v[192:195]
    s_mov_b64 exec, -1
    s_waitcnt lgkmcnt(0)
    s_barrier
    s_cmp_eq_u32 s3, 0
    s_cbranch_scc0 L_fin
    ds_read2_b32 v[192:193], v116 offset0:0 offset1:16
    ds_read2_b32 v[194:195], v116 offset0:32 offset1:48
    s_waitcnt lgkmcnt(0)
    v_pk_add_f32 v[192:193], v[192:193], v[194:195]
    v_add_f32 v192, v192, v193
    v_mov_b32 v193, v192
    s_nop 1
    v_permlane16_swap_b32 v192, v193
    v_add_f32 v192, v192, v193
    v_mov_b32 v193, v192
    s_nop 1
    v_permlane32_swap_b32 v192, v193
    v_add_f32 v192, v192, v193
    v_cvt_pk_bf16_f32 v192, v192, v192
    v_lshlrev_b32 v192, 16, v192
    v_add_f32 v192, v192, v180
    s_nop 1
    v_mov_b32_dpp v193, v192 quad_perm:[1,1,3,3] row_mask:0xf bank_mask:0xf
    v_cvt_pk_bf16_f32 v192, v192, v193
    s_mov_b64 exec, 0x5555
    buffer_store_dword v192, v117, s[28:31], 0 offen
    s_mov_b64 exec, 1
    s_or_b32 s60, s36, s37
    s_or_b32 s60, s60, s3
    s_cmp_eq_u32 s60, 0
    s_cbranch_scc0 L_fin
    v_mov_b32 v194, s34
    v_mov_b32 v195, 0
    buffer_store_dword v194, v195, s[12:15], 0 offen sc1
    s_branch L_fin
.p2align 12
L_ffn:
    s_mov_b32 s56, 4608
    s_mov_b32 s57, 9216
    s_mov_b32 s58, 13824
    s_mov_b32 s59, 18432
    s_mov_b32 s60, 23040
    s_mov_b32 s61, 27648
    s_mov_b32 s62, 32256
    buffer_load_dword v174, v121, s[12:15], 0 offen sc1
    s_lshl_b32 s48, s36, 7
    s_add_u32 s48, s48, 1835008
    v_mov_b32 v222, s34
    v_lshlrev_b32 v223, 15, v1
    v_add_u32 v223, s48, v223
    v_lshlrev_b32 v208, 16, v80
    v_and_b32 v209, 0xffff0000, v80
    v_lshlrev_b32 v210, 16, v81
    v_and_b32 v211, 0xffff0000, v81
    v_lshlrev_b32 v212, 16, v82
    ds_read_b64_tr_b16 a[128:129], v110 offset:0
    ds_read_b64_tr_b16 a[130:131], v110 offset:256
    ds_read_b64_tr_b16 a[132:133], v110 offset:4096
    ds_read_b64_tr_b16 a[134:135], v110 offset:4352
    ds_read_b64_tr_b16 a[136:137], v110 offset:8192
    ds_read_b64_tr_b16 a[138:139], v110 offset:8448
    ds_read_b64_tr_b16 a[140:141], v110 offset:12288
    ds_read_b64_tr_b16 a[142:143], v110 offset:12544
    ds_read_b64_tr_b16 a[144:145], v110 offset:16384
    ds_read_b64_tr_b16 a[146:147], v110 offset:16640
    ds_read_b64_tr_b16 a[148:149], v110 offset:20480
    ds_read_b64_tr_b16 a[150:151], v110 offset:20736
    ds_read_b64_tr_b16 a[152:153], v110 offset:24576
    ds_read_b64_tr_b16 a[154:155], v110 offset:24832
    ds_read_b64_tr_b16 a[156:157], v110 offset:28672
    ds_read_b64_tr_b16 a[158:159], v110 offset:28928
    ds_read_b64_tr_b16 a[160:161], v110 offset:32768
    ds_read_b64_tr_b16 a[162:163], v110 offset:33024
    ds_read_b64_tr_b16 a[164:165], v111 offset:0
    ds_read_b64_tr_b16 a[166:167], v111 offset:256
    ds_read_b64_tr_b16 a[168:169], v111 offset:4096
    ds_read_b64_tr_b16 a[170:171], v111 offset:4352
    ds_read_b64_tr_b16 a[172:173], v111 offset:8192
    ds_read_b64_tr_b16 a[174:175], v111 offset:8448
    ds_read_b64_tr_b16 a[176:177], v111 offset:12288
    ds_read_b64_tr_b16 a[178:179], v111 offset:12544
    ds_read_b64_tr_b16 a[180:181], v111 offset:16384
    ds_read_b64_tr_b16 a[182:183], v111 offset:16640
    ds_read_b64_tr_b16 a[184:185], v111 offset:20480
    ds_read_b64_tr_b16 a[186:187], v111 offset:20736
    ds_read_b64_tr_b16 a[188:189], v111 offset:24576
    ds_read_b64_tr_b16 a[190:191], v111 offset:24832
    ds_read_b64_tr_b16 a[192:193], v111 offset:28672
    ds_read_b64_tr_b16 a[194:195], v111 offset:28928
    ds_read_b64_tr_b16 a[196:197], v111 offset:32768
    ds_read_b64_tr_b16 a[198:199], v111 offset:33024
    s_waitcnt vmcnt(1)
    s_barrier
    ds_read_b64_tr_b16 a[200:201], v112 offset:0
    ds_read_b64_tr_b16 a[202:203], v112 offset:4608
    ds_read_b64_tr_b16 a[204:205], v113 offset:0
    ds_read_b64_tr_b16 a[206:207], v113 offset:4608
    ds_read_b64_tr_b16 a[208:209], v114 offset:0
    ds_read_b64_tr_b16 a[210:211], v114 offset:4608
    ds_read_b64_tr_b16 a[212:213], v115 offset:0
    ds_read_b64_tr_b16 a[214:215], v115 offset:4608
    ds_read_b64_tr_b16 a[216:217], v112 offset:128
    ds_read_b64_tr_b16 a[218:219], v112 offset:4736
    ds_read_b64_tr_b16 a[220:221], v113 offset:128
    ds_read_b64_tr_b16 a[222:223], v113 offset:4736
    ds_read_b64_tr_b16 a[224:225], v114 offset:128
    ds_read_b64_tr_b16 a[226:227], v114 offset:4736
    ds_read_b64_tr_b16 a[228:229], v115 offset:128
    ds_read_b64_tr_b16 a[230:231], v115 offset:4736
    ds_read_b64_tr_b16 a[232:233], v112 offset:256
    ds_read_b64_tr_b16 a[234:235], v112 offset:4864
    s_mov_b32 s70, 0x01010101
    s_mov_b32 s71, 0x01010101
    s_mov_b32 s50, 65536
L_poll96:
    s_waitcnt vmcnt(0)
    v_cmp_eq_u32 vcc, s34, v174
    s_lshr_b64 s[92:93], vcc, 4
    s_and_b64 vcc, vcc, s[92:93]
    s_lshr_b64 s[92:93], vcc, 2
    s_and_b64 vcc, vcc, s[92:93]
    s_lshr_b64 s[92:93], vcc, 1
    s_and_b64 vcc, vcc, s[92:93]
    s_and_b64 vcc, vcc, s[70:71]
    s_cbranch_scc0 L_f2a97
    s_andn2_b64 s[70:71], s[70:71], vcc
    s_bitcmp1_b64 vcc, 0
    s_cbranch_scc0 L_g98
    buffer_load_dwordx4 v[128:131], v116, s[12:15], 0 offen sc1
    buffer_load_dword v160, v117, s[12:15], 0 offen sc1
L_g98:
    s_bitcmp1_b64 vcc, 8
    s_cbranch_scc0 L_g99
    buffer_load_dwordx4 v[132:135], v116, s[12:15], s56 offen sc1
    buffer_load_dword v161, v117, s[12:15], s56 offen sc1
L_g99:
    s_bitcmp1_b64 vcc, 16
    s_cbranch_scc0 L_g100
    buffer_load_dwordx4 v[136:139], v116, s[12:15], s57 offen sc1
    buffer_load_dword v162, v117, s[12:15], s57 offen sc1
L_g100:
    s_bitcmp1_b64 vcc, 24
    s_cbranch_scc0 L_g101
    buffer_load_dwordx4 v[140:143], v116, s[12:15], s58 offen sc1
    buffer_load_dword v163, v117, s[12:15], s58 offen sc1
L_g101:
    s_bitcmp1_b64 vcc, 32
    s_cbranch_scc0 L_g102
    buffer_load_dwordx4 v[144:147], v116, s[12:15], s59 offen sc1
    buffer_load_dword v164, v117, s[12:15], s59 offen sc1
L_g102:
    s_bitcmp1_b64 vcc, 40
    s_cbranch_scc0 L_g103
    buffer_load_dwordx4 v[148:151], v116, s[12:15], s60 offen sc1
    buffer_load_dword v165, v117, s[12:15], s60 offen sc1
L_g103:
    s_bitcmp1_b64 vcc, 48
    s_cbranch_scc0 L_g104
    buffer_load_dwordx4 v[152:155], v116, s[12:15], s61 offen sc1
    buffer_load_dword v166, v117, s[12:15], s61 offen sc1
L_g104:
    s_bitcmp1_b64 vcc, 56
    s_cbranch_scc0 L_g105
    buffer_load_dwordx4 v[156:159], v116, s[12:15], s62 offen sc1
    buffer_load_dword v167, v117, s[12:15], s62 offen sc1
L_g105:
    s_cmp_eq_u64 s[70:71], 0
    s_cbranch_scc1 L_f2all93
L_f2a97:
    s_sub_u32 s50, s50, 1
    s_cbranch_scc1 L_sweep94
    buffer_load_dword v174, v121, s[12:15], 0 offen sc1
    s_branch L_poll96
L_f2all93:
    s_mov_b32 s50, 65536
L_e2106:
    s_waitcnt vmcnt(0)
    v_pk_add_f32 v[176:177], v[128:129], v[132:133]
    v_pk_add_f32 v[178:179], v[130:131], v[134:135]
    v_pk_add_f32 v[168:169], v[160:161], 0
    v_pk_add_f32 v[176:177], v[176:177], v[136:137]
    v_pk_add_f32 v[178:179], v[178:179], v[138:139]
    v_pk_add_f32 v[176:177], v[176:177], v[140:141]
    v_pk_add_f32 v[178:179], v[178:179], v[142:143]
    v_pk_add_f32 v[168:169], v[162:163], v[168:169]
    v_pk_add_f32 v[176:177], v[176:177], v[144:145]
    v_pk_add_f32 v[178:179], v[178:179], v[146:147]
    v_pk_add_f32 v[176:177], v[176:177], v[148:149]
    v_pk_add_f32 v[178:179], v[178:179], v[150:151]
    v_pk_add_f32 v[168:169], v[164:165], v[168:169]
    v_pk_add_f32 v[176:177], v[176:177], v[152:153]
    v_pk_add_f32 v[178:179], v[178:179], v[154:155]
    v_pk_add_f32 v[176:177], v[176:177], v[156:157]
    v_pk_add_f32 v[178:179], v[178:179], v[158:159]
    v_pk_add_f32 v[168:169], v[166:167], v[168:169]
    v_pk_add_f32 v[170:171], v[176:177], v[178:179]
    v_add_f32 v180, v168, v169
    v_add_f32 v170, v170, v171
    v_cmp_u_f32 vcc, v180, v170
    s_cbranch_vccz L_e2ok107
    s_sub_u32 s50, s50, 1
    s_cbranch_scc1 L_e2ok107
L_sweep94:
    s_and_b32 s50, s50, 0x1ffff
    buffer_load_dwordx4 v[128:131], v116, s[12:15], 0 offen sc1
    buffer_load_dword v160, v117, s[12:15], 0 offen sc1
    buffer_load_dwordx4 v[132:135], v116, s[12:15], s56 offen sc1
    buffer_load_dword v161, v117, s[12:15], s56 offen sc1
    buffer_load_dwordx4 v[136:139], v116, s[12:15], s57 offen sc1
    buffer_load_dword v162, v117, s[12:15], s57 offen sc1
    buffer_load_dwordx4 v[140:143], v116, s[12:15], s58 offen sc1
    buffer_load_dword v163, v117, s[12:15], s58 offen sc1
    buffer_load_dwordx4 v[144:147], v116, s[12:15], s59 offen sc1
    buffer_load_dword v164, v117, s[12:15], s59 offen sc1
    buffer_load_dwordx4 v[148:151], v116, s[12:15], s60 offen sc1
    buffer_load_dword v165, v117, s[12:15], s60 offen sc1
    buffer_load_dwordx4 v[152:155], v116, s[12:15], s61 offen sc1
    buffer_load_dword v166, v117, s[12:15], s61 offen sc1
    buffer_load_dwordx4 v[156:159], v116, s[12:15], s62 offen sc1
    buffer_load_dword v167, v117, s[12:15], s62 offen sc1
    s_branch L_e2106
L_e2ok107:
    v_cvt_pk_bf16_f32 v177, v176, v177
    v_cvt_pk_bf16_f32 v179, v178, v179
    v_lshlrev_b32 v176, 16, v177
    v_and_b32 v177, 0xffff0000, v177
    v_cvt_pk_bf16_f32 v180, v180, v180
    v_lshlrev_b32 v178, 16, v179
    v_and_b32 v179, 0xffff0000, v179
    v_lshlrev_b32 v180, 16, v180
    v_pk_add_f32 v[176:177], v[176:177], v[208:209]
    v_pk_add_f32 v[178:179], v[178:179], v[210:211]
    v_add_f32 v180, v180, v212
    v_cvt_pk_bf16_f32 v177, v176, v177
    v_cvt_pk_bf16_f32 v179, v178, v179
    v_cvt_pk_bf16_f32 v180, v180, v180
    v_mov_b32 v194, v177
    v_mov_b32 v195, v179
    ds_write_b64 v87, v[194:195]
    ds_write_b16 v88, v180
    v_lshlrev_b32 v176, 16, v177
    v_and_b32 v177, 0xffff0000, v177
    v_lshlrev_b32 v178, 16, v179
    v_and_b32 v179, 0xffff0000, v179
    v_lshlrev_b32 v180, 16, v180
    v_readfirstlane_b32 s48, v176
    s_nop 1
    v_subrev_f32 v184, s48, v176
    v_subrev_f32 v185, s48, v177
    v_subrev_f32 v186, s48, v178
    v_subrev_f32 v187, s48, v179
    v_subrev_f32 v188, s48, v180
    v_mul_f32 v189, 0.5, v188
    v_add_f32 v190, v184, v185
    v_mul_f32 v191, v184, v184
    v_add_f32 v190, v190, v186
    v_fmac_f32 v191, v185, v185
    v_add_f32 v190, v190, v187
    v_fmac_f32 v191, v186, v186
    v_add_f32 v190, v190, v189
    v_fmac_f32 v191, v187, v187
    v_mov_b32 v192, s48
    v_fmac_f32 v191, v189, v188
    v_add_f32_dpp v190, v190, v190 quad_perm:[1,0,3,2] row_mask:0xf bank_mask:0xf
    s_nop 0
    v_add_f32_dpp v191, v191, v191 quad_perm:[1,0,3,2] row_mask:0xf bank_mask:0xf
    v_add_f32_dpp v190, v190, v190 quad_perm:[2,3,0,1] row_mask:0xf bank_mask:0xf
    s_nop 0
    v_add_f32_dpp v191, v191, v191 quad_perm:[2,3,0,1] row_mask:0xf bank_mask:0xf
    v_add_f32_dpp v190, v190, v190 row_half_mirror row_mask:0xf bank_mask:0xf
    s_nop 0
    v_add_f32_dpp v191, v191, v191 row_half_mirror row_mask:0xf bank_mask:0xf
    v_add_f32_dpp v190, v190, v190 row_mirror row_mask:0xf bank_mask:0xf
    s_nop 0
    v_add_f32_dpp v191, v191, v191 row_mirror row_mask:0xf bank_mask:0xf
    v_add_f32_dpp v190, v190, v190 row_bcast:15 row_mask:0xa bank_mask:0xf
    s_nop 0
    v_add_f32_dpp v191, v191, v191 row_bcast:15 row_mask:0xa bank_mask:0xf
    v_add_f32_dpp v190, v190, v190 row_bcast:31 row_mask:0xc bank_mask:0xf
    s_nop 0
    v_add_f32_dpp v191, v191, v191 row_bcast:31 row_mask:0xc bank_mask:0xf
    s_mov_b32 exec_lo, 0
    s_mov_b32 exec_hi, 0x80000000
    ds_write_b96 v89, v[190:192]
    s_mov_b64 exec, -1
    s_waitcnt lgkmcnt(0)
    s_barrier
    ds_read_b96 v[194:196], v123
    ds_read_b96 v[198:200], v123 offset:16
    s_cmp_eq_u32 s3, 3
    s_cbranch_scc0 L_fl108
    s_mov_b64 exec, 255
    buffer_store_dword v222, v223, s[12:15], 0 offen sc1
    s_mov_b64 exec, -1
L_fl108:
    ds_read_b128 a[0:3], v122 offset:0
    ds_read_b128 a[4:7], v122 offset:64
    ds_read_b128 a[8:11], v122 offset:128
    ds_read_b128 a[12:15], v122 offset:192
    ds_read_b128 a[16:19], v122 offset:256
    ds_read_b128 a[20:23], v122 offset:320
    ds_read_b128 a[24:27], v122 offset:384
    ds_read_b128 a[28:31], v122 offset:448
    ds_read_b128 a[32:35], v122 offset:512
    ds_read_b128 a[36:39], v122 offset:576
    ds_read_b128 a[40:43], v122 offset:640
    ds_read_b128 a[44:47], v122 offset:704
    ds_read_b128 a[48:51], v122 offset:768
    s_waitcnt lgkmcnt(12)
    v_mfma_f32_16x16x32_bf16 v[128:131], a[0:3], a[128:131], 0
    ds_read_b128 a[52:55], v122 offset:832
    ds_read_b128 a[56:59], v122 offset:896
    ds_read_b128 a[60:63], v122 offset:960
    v_mul_f32 v184, 0x3b638e39, v194
    v_mul_f32 v185, 0x3b638e39, v198
    s_waitcnt lgkmcnt(14)
    v_mfma_f32_16x16x32_bf16 v[128:131], a[4:7], a[132:135], v[128:131]
    ds_read_b128 a[64:67], v122 offset:1024
    v_fma_f32 v195, -v184, v194, v195
    v_fma_f32 v199, -v185, v198, v199
    s_waitcnt lgkmcnt(14)
    v_mfma_f32_16x16x32_bf16 v[128:131], a[8:11], a[136:139], v[128:131]
    ds_read_b128 a[68:71], v122 offset:1088
    v_add_f32 v184, v184, v196
    v_add_f32 v185, v185, v200
    s_waitcnt lgkmcnt(14)
    v_mfma_f32_16x16x32_bf16 v[128:131], a[12:15], a[140:143], v[128:131]
    v_add_f32 v195, v195, v199
    v_sub_f32 v194, v184, v185
    s_waitcnt lgkmcnt(13)
    v_mfma_f32_16x16x32_bf16 v[128:131], a[16:19], a[144:147], v[128:131]
    v_add_f32 v184, v184, v185
    v_mul_f32 v198, 0x43100000, v194
    s_waitcnt lgkmcnt(12)
    v_mfma_f32_16x16x32_bf16 v[128:131], a[20:23], a[148:151], v[128:131]
    v_mul_f32 v184, 0.5, v184
    v_fmac_f32 v195, v198, v194
    s_waitcnt lgkmcnt(11)
    v_mfma_f32_16x16x32_bf16 v[128:131], a[24:27], a[152:155], v[128:131]
    v_mul_f32 v195, 0x3ae38e39, v195
    v_max_f32 v195, 0, v195
    s_waitcnt lgkmcnt(10)
    v_mfma_f32_16x16x32_bf16 v[128:131], a[28:31], a[156:159], v[128:131]
    v_cvt_pk_bf16_f32 v184, v184, v195
    v_and_b32 v191, 0xffff0000, v184
    s_waitcnt lgkmcnt(9)
    v_mfma_f32_16x16x32_bf16 v[128:131], a[32:35], a[160:163], v[128:131]
    v_lshlrev_b32 v190, 16, v184
    v_add_f32 v191, 0x3727c5ac, v191
    s_waitcnt lgkmcnt(8)
    v_mfma_f32_16x16x32_bf16 v[128:131], a[36:39], a[164:167], v[128:131]
    v_cvt_pk_bf16_f32 v191, v191, v191
    v_lshlrev_b32 v191, 16, v191
    s_waitcnt lgkmcnt(7)
    v_mfma_f32_16x16x32_bf16 v[128:131], a[40:43], a[168:171], v[128:131]
    v_sqrt_f32 v191, v191
    s_nop 0
    v_cvt_pk_bf16_f32 v191, v191, v191
    s_waitcnt lgkmcnt(6)
    v_mfma_f32_16x16x32_bf16 v[128:131], a[44:47], a[172:175], v[128:131]
    v_lshlrev_b32 v191, 16, v191
    v_rcp_f32 v191, v191
    s_waitcnt lgkmcnt(5)
    v_mfma_f32_16x16x32_bf16 v[128:131], a[48:51], a[176:179], v[128:131]
    s_waitcnt lgkmcnt(4)
    v_mfma_f32_16x16x32_bf16 v[128:131], a[52:55], a[180:183], v[128:131]
    s_waitcnt lgkmcnt(3)
    v_mfma_f32_16x16x32_bf16 v[128:131], a[56:59], a[184:187], v[128:131]
    s_waitcnt lgkmcnt(2)
    v_mfma_f32_16x16x32_bf16 v[128:131], a[60:63], a[188:191], v[128:131]
    s_waitcnt lgkmcnt(1)
    v_mfma_f32_16x16x32_bf16 v[128:131], a[64:67], a[192:195], v[128:131]
    s_waitcnt lgkmcnt(0)
    v_mfma_f32_16x16x32_bf16 v[128:131], a[68:71], a[196:199], v[128:131]
    s_nop 7
    v_mov_b32 v132, v128
    v_mov_b32 v133, v129
    v_mov_b32_dpp v132, v129 row_shr:8 row_mask:0xf bank_mask:0xc
    v_mov_b32_dpp v133, v128 row_shl:8 row_mask:0xf bank_mask:0x3
    v_mov_b32 v134, v130
    v_mov_b32 v135, v130
    v_mov_b32_dpp v134, v130 row_shr:8 row_mask:0xf bank_mask:0xc
    v_mov_b32_dpp v135, v130 row_shl:8 row_mask:0xf bank_mask:0x3
    v_fma_f32 v132, -v190, v134, v132
    v_fma_f32 v133, -v190, v135, v133
    v_mul_f32 v132, v132, v191
    v_mul_f32 v133, v133, v191
    v_cvt_pk_bf16_f32 v133, v132, v133
    v_lshlrev_b32 v132, 16, v133
    v_and_b32 v133, 0xffff0000, v133
    v_mul_f32 v134, s39, v132
    v_exp_f32 v134, -v134
    s_nop 0
    v_add_f32 v134, 1.0, v134
    v_rcp_f32 v134, v134
    s_nop 0
    v_mul_f32 v134, v132, v134
    v_cvt_pk_bf16_f32 v134, v134, v134
    v_lshlrev_b32 v134, 16, v134
    v_mul_f32 v134, v134, v133
    v_cvt_pk_bf16_f32 v134, v134, v134
    s_mov_b64 exec, 0xffff
    ds_write_b16 v118, v134
    s_mov_b64 exec, -1
    s_waitcnt lgkmcnt(0)
    s_barrier
    ds_read_b128 v[136:139], v224
    ds_read_b128 v[140:143], v225
    ds_read_b128 v[144:147], v226
    ds_read_b128 v[148:151], v227
    ds_read_b128 v[152:155], v228
    ds_read_b128 v[156:159], v229
    ds_read_b128 v[160:163], v230
    ds_read_b128 v[164:167], v231
    ds_read_b128 v[168:171], v224
    s_waitcnt lgkmcnt(8)
    v_mfma_f32_16x16x32_bf16 v[176:179], a[200:203], v[136:139], 0
    s_waitcnt lgkmcnt(7)
    v_mfma_f32_16x16x32_bf16 v[176:179], a[204:207], v[140:143], v[176:179]
    s_waitcnt lgkmcnt(6)
    v_mfma_f32_16x16x32_bf16 v[176:179], a[208:211], v[144:147], v[176:179]
    s_waitcnt lgkmcnt(5)
    v_mfma_f32_16x16x32_bf16 v[176:179], a[212:215], v[148:151], v[176:179]
    s_waitcnt lgkmcnt(4)
    v_mfma_f32_16x16x32_bf16 v[176:179], a[216:219], v[152:155], v[176:179]
    s_waitcnt lgkmcnt(3)
    v_mfma_f32_16x16x32_bf16 v[176:179], a[220:223], v[156:159], v[176:179]
    s_waitcnt lgkmcnt(2)
    v_mfma_f32_16x16x32_bf16 v[176:179], a[224:227], v[160:163], v[176:179]
    s_waitcnt lgkmcnt(1)
    v_mfma_f32_16x16x32_bf16 v[176:179], a[228:231], v[164:167], v[176:179]
    s_waitcnt lgkmcnt(0)
    v_mfma_f32_16x16x32_bf16 v[180:183], a[232:235], v[168:171], 0
    s_mov_b32 s60, 147456
    s_nop 5
    buffer_store_dwordx4 v[176:179], v232, s[12:15], 0 offen sc1
    s_mov_b32 exec_lo, 0x30003
    s_mov_b32 exec_hi, 0x30003
    buffer_store_dwordx4 v[180:183], v120, s[12:15], s60 offen sc1
L_fin:
L_end:
    s_endpgm
L_help:
    s_cmp_eq_u32 s35, 0
    s_cbranch_scc0 L_hf109
    s_mov_b32 m0, s78
    s_nop 0
    buffer_load_dwordx4 v100, s[20:23], s77 offen nt lds
    s_add_u32 s78, s78, 1024
    s_mov_b32 m0, s78
    s_nop 0
    buffer_load_dwordx4 v101, s[20:23], s77 offen nt lds
    s_add_u32 s78, s78, 1024
    s_mov_b32 m0, s78
    s_nop 0
    buffer_load_dwordx4 v102, s[20:23], s77 offen nt lds
    s_add_u32 s78, s78, 1024
    s_add_u32 s77, s77, 36864
    s_waitcnt vmcnt(2)
    s_mov_b32 m0, s78
    s_nop 0
    buffer_load_dwordx4 v100, s[20:23], s77 offen nt lds
    s_add_u32 s78, s78, 1024
    s_mov_b32 m0, s78
    s_nop 0
    buffer_load_dwordx4 v101, s[20:23], s77 offen nt lds
    s_add_u32 s78, s78, 1024
    s_mov_b32 m0, s78
    s_nop 0
    buffer_load_dwordx4 v102, s[20:23], s77 offen nt lds
    s_add_u32 s78, s78, 1024
    s_add_u32 s77, s77, 36864
    s_waitcnt vmcnt(2)
    s_mov_b32 m0, s78
    s_nop 0
    buffer_load_dwordx4 v100, s[20:23], s77 offen nt lds
    s_add_u32 s78, s78, 1024
    s_mov_b32 m0, s78
    s_nop 0
    buffer_load_dwordx4 v101, s[20:23], s77 offen nt lds
    s_add_u32 s78, s78, 1024
    s_mov_b32 m0, s78
    s_nop 0
    buffer_load_dwordx4 v102, s[20:23], s77 offen nt lds
    s_add_u32 s78, s78, 1024
    s_add_u32 s77, s77, 36864
    s_waitcnt vmcnt(2)
    s_mov_b32 m0, s78
    s_nop 0
    buffer_load_dwordx4 v100, s[20:23], s77 offen nt lds
    s_add_u32 s78, s78, 1024
    s_mov_b32 m0, s78
    s_nop 0
    buffer_load_dwordx4 v101, s[20:23], s77 offen nt lds
    s_add_u32 s78, s78, 1024
    s_mov_b32 m0, s78
    s_nop 0
    buffer_load_dwordx4 v102, s[20:23], s77 offen nt lds
    s_add_u32 s78, s78, 1024
    s_add_u32 s77, s77, 36864
    s_waitcnt vmcnt(2)
    s_mov_b32 m0, s78
    s_nop 0
    buffer_load_dwordx4 v100, s[20:23], s77 offen nt lds
    s_add_u32 s78, s78, 1024
    s_mov_b32 m0, s78
    s_nop 0
    buffer_load_dwordx4 v101, s[20:23], s77 offen nt lds
    s_add_u32 s78, s78, 1024
    s_mov_b32 m0, s78
    s_nop 0
    buffer_load_dwordx4 v102, s[20:23], s77 offen nt lds
    s_add_u32 s78, s78, 1024
    s_add_u32 s77, s77, 36864
    s_waitcnt vmcnt(2)
    s_mov_b32 m0, s78
    s_nop 0
    buffer_load_dwordx4 v100, s[20:23], s77 offen nt lds
    s_add_u32 s78, s78, 1024
    s_mov_b32 m0, s78
    s_nop 0
    buffer_load_dwordx4 v101, s[20:23], s77 offen nt lds
    s_add_u32 s78, s78, 1024
    s_mov_b32 m0, s78
    s_nop 0
    buffer_load_dwordx4 v102, s[20:23], s77 offen nt lds
    s_add_u32 s78, s78, 1024
    s_add_u32 s77, s77, 36864
    s_waitcnt vmcnt(2)
    s_branch L_he110
L_hf109:
    s_cmp_eq_u32 s35, 1
    s_cbranch_scc0 L_he110
    s_mul_i32 s60, s59, 1152
    s_add_u32 s61, s60, 0
    v_add_u32 v132, s61, v1
    v_mul_u32_u24 v133, 14564, v132
    v_lshrrev_b32 v133, 20, v133
    v_and_b32 v134, 2, v133
    v_bfe_u32 v133, v133, 3, 1
    v_lshl_or_b32 v133, v133, 2, v134
    v_xor_b32 v132, v132, v133
    v_lshlrev_b32 v202, 4, v132
    s_add_u32 s61, s60, 64
    v_add_u32 v132, s61, v1
    v_mul_u32_u24 v133, 14564, v132
    v_lshrrev_b32 v133, 20, v133
    v_and_b32 v134, 2, v133
    v_bfe_u32 v133, v133, 3, 1
    v_lshl_or_b32 v133, v133, 2, v134
    v_xor_b32 v132, v132, v133
    v_lshlrev_b32 v203, 4, v132
    s_add_u32 s61, s60, 128
    v_add_u32 v132, s61, v1
    v_mul_u32_u24 v133, 14564, v132
    v_lshrrev_b32 v133, 20, v133
    v_and_b32 v134, 2, v133
    v_bfe_u32 v133, v133, 3, 1
    v_lshl_or_b32 v133, v133, 2, v134
    v_xor_b32 v132, v132, v133
    v_lshlrev_b32 v204, 4, v132
    s_add_u32 s61, s60, 192
    v_add_u32 v132, s61, v1
    v_mul_u32_u24 v133, 14564, v132
    v_lshrrev_b32 v133, 20, v133
    v_and_b32 v134, 2, v133
    v_bfe_u32 v133, v133, 3, 1
    v_lshl_or_b32 v133, v133, 2, v134
    v_xor_b32 v132, v132, v133
    v_lshlrev_b32 v205, 4, v132
    s_add_u32 s61, s60, 256
    v_add_u32 v132, s61, v1
    v_mul_u32_u24 v133, 14564, v132
    v_lshrrev_b32 v133, 20, v133
    v_and_b32 v134, 2, v133
    v_bfe_u32 v133, v133, 3, 1
    v_lshl_or_b32 v133, v133, 2, v134
    v_xor_b32 v132, v132, v133
    v_lshlrev_b32 v206, 4, v132
    s_add_u32 s61, s60, 320
    v_add_u32 v132, s61, v1
    v_mul_u32_u24 v133, 14564, v132
    v_lshrrev_b32 v133, 20, v133
    v_and_b32 v134, 2, v133
    v_bfe_u32 v133, v133, 3, 1
    v_lshl_or_b32 v133, v133, 2, v134
    v_xor_b32 v132, v132, v133
    v_lshlrev_b32 v207, 4, v132
    s_add_u32 s61, s60, 384
    v_add_u32 v132, s61, v1
    v_mul_u32_u24 v133, 14564, v132
    v_lshrrev_b32 v133, 20, v133
    v_and_b32 v134, 2, v133
    v_bfe_u32 v133, v133, 3, 1
    v_lshl_or_b32 v133, v133, 2, v134
    v_xor_b32 v132, v132, v133
    v_lshlrev_b32 v208, 4, v132
    s_add_u32 s61, s60, 448
    v_add_u32 v132, s61, v1
    v_mul_u32_u24 v133, 14564, v132
    v_lshrrev_b32 v133, 20, v133
    v_and_b32 v134, 2, v133
    v_bfe_u32 v133, v133, 3, 1
    v_lshl_or_b32 v133, v133, 2, v134
    v_xor_b32 v132, v132, v133
    v_lshlrev_b32 v209, 4, v132
    s_add_u32 s61, s60, 512
    v_add_u32 v132, s61, v1
    v_mul_u32_u24 v133, 14564, v132
    v_lshrrev_b32 v133, 20, v133
    v_and_b32 v134, 2, v133
    v_bfe_u32 v133, v133, 3, 1
    v_lshl_or_b32 v133, v133, 2, v134
    v_xor_b32 v132, v132, v133
    v_lshlrev_b32 v210, 4, v132
    s_add_u32 s61, s60, 576
    v_add_u32 v132, s61, v1
    v_mul_u32_u24 v133, 14564, v132
    v_lshrrev_b32 v133, 20, v133
    v_and_b32 v134, 2, v133
    v_bfe_u32 v133, v133, 3, 1
    v_lshl_or_b32 v133, v133, 2, v134
    v_xor_b32 v132, v132, v133
    v_lshlrev_b32 v211, 4, v132
    s_add_u32 s61, s60, 640
    v_add_u32 v132, s61, v1
    v_mul_u32_u24 v133, 14564, v132
    v_lshrrev_b32 v133, 20, v133
    v_and_b32 v134, 2, v133
    v_bfe_u32 v133, v133, 3, 1
    v_lshl_or_b32 v133, v133, 2, v134
    v_xor_b32 v132, v132, v133
    v_lshlrev_b32 v212, 4, v132
    s_add_u32 s61, s60, 704
    v_add_u32 v132, s61, v1
    v_mul_u32_u24 v133, 14564, v132
    v_lshrrev_b32 v133, 20, v133
    v_and_b32 v134, 2, v133
    v_bfe_u32 v133, v133, 3, 1
    v_lshl_or_b32 v133, v133, 2, v134
    v_xor_b32 v132, v132, v133
    v_lshlrev_b32 v213, 4, v132
    s_add_u32 s61, s60, 768
    v_add_u32 v132, s61, v1
    v_mul_u32_u24 v133, 14564, v132
    v_lshrrev_b32 v133, 20, v133
    v_and_b32 v134, 2, v133
    v_bfe_u32 v133, v133, 3, 1
    v_lshl_or_b32 v133, v133, 2, v134
    v_xor_b32 v132, v132, v133
    v_lshlrev_b32 v214, 4, v132
    s_add_u32 s61, s60, 832
    v_add_u32 v132, s61, v1
    v_mul_u32_u24 v133, 14564, v132
    v_lshrrev_b32 v133, 20, v133
    v_and_b32 v134, 2, v133
    v_bfe_u32 v133, v133, 3, 1
    v_lshl_or_b32 v133, v133, 2, v134
    v_xor_b32 v132, v132, v133
    v_lshlrev_b32 v215, 4, v132
    s_add_u32 s61, s60, 896
    v_add_u32 v132, s61, v1
    v_mul_u32_u24 v133, 14564, v132
    v_lshrrev_b32 v133, 20, v133
    v_and_b32 v134, 2, v133
    v_bfe_u32 v133, v133, 3, 1
    v_lshl_or_b32 v133, v133, 2, v134
    v_xor_b32 v132, v132, v133
    v_lshlrev_b32 v216, 4, v132
    s_add_u32 s61, s60, 960
    v_add_u32 v132, s61, v1
    v_mul_u32_u24 v133, 14564, v132
    v_lshrrev_b32 v133, 20, v133
    v_and_b32 v134, 2, v133
    v_bfe_u32 v133, v133, 3, 1
    v_lshl_or_b32 v133, v133, 2, v134
    v_xor_b32 v132, v132, v133
    v_lshlrev_b32 v217, 4, v132
    s_add_u32 s61, s60, 1024
    v_add_u32 v132, s61, v1
    v_mul_u32_u24 v133, 14564, v132
    v_lshrrev_b32 v133, 20, v133
    v_and_b32 v134, 2, v133
    v_bfe_u32 v133, v133, 3, 1
    v_lshl_or_b32 v133, v133, 2, v134
    v_xor_b32 v132, v132, v133
    v_lshlrev_b32 v218, 4, v132
    s_add_u32 s61, s60, 1088
    v_add_u32 v132, s61, v1
    v_mul_u32_u24 v133, 14564, v132
    v_lshrrev_b32 v133, 20, v133
    v_and_b32 v134, 2, v133
    v_bfe_u32 v133, v133, 3, 1
    v_lshl_or_b32 v133, v133, 2, v134
    v_xor_b32 v132, v132, v133
    v_lshlrev_b32 v219, 4, v132
    s_mov_b32 m0, s78
    s_add_u32 s60, s78, 2048
    buffer_load_dwordx4 v200, s[20:23], s77 offen nt lds
    s_mov_b32 m0, s60
    s_add_u32 s78, s78, 4096
    buffer_load_dwordx4 v201, s[64:67], s77 offen nt lds
    s_add_u32 s77, s77, 294912
    s_waitcnt vmcnt(2)
    s_mov_b32 m0, s78
    s_add_u32 s60, s78, 2048
    buffer_load_dwordx4 v200, s[20:23], s77 offen nt lds
    s_mov_b32 m0, s60
    s_add_u32 s78, s78, 4096
    buffer_load_dwordx4 v201, s[64:67], s77 offen nt lds
    s_add_u32 s77, s77, 294912
    s_waitcnt vmcnt(2)
    s_mov_b32 m0, s78
    s_add_u32 s60, s78, 2048
    buffer_load_dwordx4 v200, s[20:23], s77 offen nt lds
    s_mov_b32 m0, s60
    s_add_u32 s78, s78, 4096
    buffer_load_dwordx4 v201, s[64:67], s77 offen nt lds
    s_add_u32 s77, s77, 294912
    s_waitcnt vmcnt(2)
    s_mov_b32 m0, s78
    s_add_u32 s60, s78, 2048
    buffer_load_dwordx4 v200, s[20:23], s77 offen nt lds
    s_mov_b32 m0, s60
    s_add_u32 s78, s78, 4096
    buffer_load_dwordx4 v201, s[64:67], s77 offen nt lds
    s_add_u32 s77, s77, 294912
    s_waitcnt vmcnt(2)
    s_mov_b32 m0, s78
    s_add_u32 s60, s78, 2048
    buffer_load_dwordx4 v200, s[20:23], s77 offen nt lds
    s_mov_b32 m0, s60
    s_add_u32 s78, s78, 4096
    buffer_load_dwordx4 v201, s[64:67], s77 offen nt lds
    s_add_u32 s77, s77, 294912
    s_waitcnt vmcnt(2)
    s_mov_b32 m0, s78
    s_add_u32 s60, s78, 2048
    buffer_load_dwordx4 v200, s[20:23], s77 offen nt lds
    s_mov_b32 m0, s60
    s_add_u32 s78, s78, 4096
    buffer_load_dwordx4 v201, s[64:67], s77 offen nt lds
    s_add_u32 s77, s77, 294912
    s_waitcnt vmcnt(2)
    s_mov_b32 m0, s78
    s_add_u32 s60, s78, 2048
    buffer_load_dwordx4 v200, s[20:23], s77 offen nt lds
    s_mov_b32 m0, s60
    s_add_u32 s78, s78, 4096
    buffer_load_dwordx4 v201, s[64:67], s77 offen nt lds
    s_add_u32 s77, s77, 294912
    s_waitcnt vmcnt(2)
    s_mov_b32 m0, s78
    s_add_u32 s60, s78, 2048
    buffer_load_dwordx4 v200, s[20:23], s77 offen nt lds
    s_mov_b32 m0, s60
    s_add_u32 s78, s78, 4096
    buffer_load_dwordx4 v201, s[64:67], s77 offen nt lds
    s_add_u32 s77, s77, 294912
    s_waitcnt vmcnt(2)
    s_mov_b32 m0, s78
    s_add_u32 s60, s78, 2048
    buffer_load_dwordx4 v200, s[20:23], s77 offen nt lds
    s_mov_b32 m0, s60
    s_add_u32 s78, s78, 4096
    buffer_load_dwordx4 v201, s[64:67], s77 offen nt lds
    s_add_u32 s77, s77, 294912
    s_waitcnt vmcnt(2)
    s_mov_b32 m0, s78
    s_add_u32 s60, s78, 2048
    buffer_load_dwordx4 v200, s[20:23], s77 offen nt lds
    s_mov_b32 m0, s60
    s_add_u32 s78, s78, 4096
    buffer_load_dwordx4 v201, s[64:67], s77 offen nt lds
    s_add_u32 s77, s77, 294912
    s_waitcnt vmcnt(2)
    s_mov_b32 m0, s78
    s_add_u32 s60, s78, 2048
    buffer_load_dwordx4 v200, s[20:23], s77 offen nt lds
    s_mov_b32 m0, s60
    s_add_u32 s78, s78, 4096
    buffer_load_dwordx4 v201, s[64:67], s77 offen nt lds
    s_add_u32 s77, s77, 294912
    s_waitcnt vmcnt(2)
    s_mov_b32 m0, s78
    s_add_u32 s60, s78, 2048
    buffer_load_dwordx4 v200, s[20:23], s77 offen nt lds
    s_mov_b32 m0, s60
    s_add_u32 s78, s78, 4096
    buffer_load_dwordx4 v201, s[64:67], s77 offen nt lds
    s_add_u32 s77, s77, 294912
    s_waitcnt vmcnt(2)
    s_mov_b32 m0, s78
    s_add_u32 s60, s78, 2048
    buffer_load_dwordx4 v200, s[20:23], s77 offen nt lds
    s_mov_b32 m0, s60
    s_add_u32 s78, s78, 4096
    buffer_load_dwordx4 v201, s[64:67], s77 offen nt lds
    s_add_u32 s77, s77, 294912
    s_waitcnt vmcnt(2)
    s_mov_b32 m0, s78
    s_add_u32 s60, s78, 2048
    buffer_load_dwordx4 v200, s[20:23], s77 offen nt lds
    s_mov_b32 m0, s60
    s_add_u32 s78, s78, 4096
    buffer_load_dwordx4 v201, s[64:67], s77 offen nt lds
    s_add_u32 s77, s77, 294912
    s_waitcnt vmcnt(2)
    s_mov_b32 m0, s78
    s_add_u32 s60, s78, 2048
    buffer_load_dwordx4 v200, s[20:23], s77 offen nt lds
    s_mov_b32 m0, s60
    s_add_u32 s78, s78, 4096
    buffer_load_dwordx4 v201, s[64:67], s77 offen nt lds
    s_add_u32 s77, s77, 294912
    s_waitcnt vmcnt(2)
    s_mov_b32 m0, s78
    s_add_u32 s60, s78, 2048
    buffer_load_dwordx4 v200, s[20:23], s77 offen nt lds
    s_mov_b32 m0, s60
    s_add_u32 s78, s78, 4096
    buffer_load_dwordx4 v201, s[64:67], s77 offen nt lds
    s_add_u32 s77, s77, 294912
    s_waitcnt vmcnt(2)
L_he110:
    s_branch L_hlate
L_slow32:
    v_max_f32_dpp v45, v44, v44 quad_perm:[1,0,3,2] row_mask:0xf bank_mask:0xf
    s_nop 1
    v_max_f32_dpp v45, v45, v45 quad_perm:[2,3,0,1] row_mask:0xf bank_mask:0xf
    s_nop 1
    v_max_f32_dpp v45, v45, v45 row_ror:8 row_mask:0xf bank_mask:0xf
    v_mov_b32 v46, v45
    s_nop 1
    v_permlane16_swap_b32 v45, v46
    v_max_f32 v45, v45, v46
    v_mov_b32 v46, v45
    s_nop 1
    v_permlane32_swap_b32 v45, v46
    v_max3_f32 v45, v45, v46, v18
    v_sub_f32 v47, v18, v45
    v_mul_f32 v47, s39, v47
    v_exp_f32 v47, v47
    v_mov_b32 v18, v45
    v_mul_f32 v19, v19, v47
    v_readlane_b32 s48, v47, 0
    v_readlane_b32 s49, v47, 4
    s_nop 0
    v_mov_b32 v45, s48
    v_mov_b32 v46, s49
    v_cndmask_b32 v45, v45, v46, s[72:73]
    v_mul_f32 v20, v20, v45
    v_mul_f32 v21, v21, v45
    v_mul_f32 v22, v22, v45
    v_mul_f32 v23, v23, v45
    s_nop 1
    s_branch L_back33
L_slow35:
    v_max_f32_dpp v45, v44, v44 quad_perm:[1,0,3,2] row_mask:0xf bank_mask:0xf
    s_nop 1
    v_max_f32_dpp v45, v45, v45 quad_perm:[2,3,0,1] row_mask:0xf bank_mask:0xf
    s_nop 1
    v_max_f32_dpp v45, v45, v45 row_ror:8 row_mask:0xf bank_mask:0xf
    v_mov_b32 v46, v45
    s_nop 1
    v_permlane16_swap_b32 v45, v46
    v_max_f32 v45, v45, v46
    v_mov_b32 v46, v45
    s_nop 1
    v_permlane32_swap_b32 v45, v46
    v_max3_f32 v45, v45, v46, v18
    v_sub_f32 v47, v18, v45
    v_mul_f32 v47, s39, v47
    v_exp_f32 v47, v47
    v_mov_b32 v18, v45
    v_mul_f32 v19, v19, v47
    v_readlane_b32 s48, v47, 0
    v_readlane_b32 s49, v47, 4
    s_nop 0
    v_mov_b32 v45, s48
    v_mov_b32 v46, s49
    v_cndmask_b32 v45, v45, v46, s[72:73]
    v_mul_f32 v20, v20, v45
    v_mul_f32 v21, v21, v45
    v_mul_f32 v22, v22, v45
    v_mul_f32 v23, v23, v45
    s_nop 1
    s_branch L_back36
L_slow38:
    v_max_f32_dpp v45, v44, v44 quad_perm:[1,0,3,2] row_mask:0xf bank_mask:0xf
    s_nop 1
    v_max_f32_dpp v45, v45, v45 quad_perm:[2,3,0,1] row_mask:0xf bank_mask:0xf
    s_nop 1
    v_max_f32_dpp v45, v45, v45 row_ror:8 row_mask:0xf bank_mask:0xf
    v_mov_b32 v46, v45
    s_nop 1
    v_permlane16_swap_b32 v45, v46
    v_max_f32 v45, v45, v46
    v_mov_b32 v46, v45
    s_nop 1
    v_permlane32_swap_b32 v45, v46
    v_max3_f32 v45, v45, v46, v18
    v_sub_f32 v47, v18, v45
    v_mul_f32 v47, s39, v47
    v_exp_f32 v47, v47
    v_mov_b32 v18, v45
    v_mul_f32 v19, v19, v47
    v_readlane_b32 s48, v47, 0
    v_readlane_b32 s49, v47, 4
    s_nop 0
    v_mov_b32 v45, s48
    v_mov_b32 v46, s49
    v_cndmask_b32 v45, v45, v46, s[72:73]
    v_mul_f32 v20, v20, v45
    v_mul_f32 v21, v21, v45
    v_mul_f32 v22, v22, v45
    v_mul_f32 v23, v23, v45
    s_nop 1
    s_branch L_back39
L_slow41:
    v_max_f32_dpp v45, v44, v44 quad_perm:[1,0,3,2] row_mask:0xf bank_mask:0xf
    s_nop 1
    v_max_f32_dpp v45, v45, v45 quad_perm:[2,3,0,1] row_mask:0xf bank_mask:0xf
    s_nop 1
    v_max_f32_dpp v45, v45, v45 row_ror:8 row_mask:0xf bank_mask:0xf
    v_mov_b32 v46, v45
    s_nop 1
    v_permlane16_swap_b32 v45, v46
    v_max_f32 v45, v45, v46
    v_mov_b32 v46, v45
    s_nop 1
    v_permlane32_swap_b32 v45, v46
    v_max3_f32 v45, v45, v46, v18
    v_sub_f32 v47, v18, v45
    v_mul_f32 v47, s39, v47
    v_exp_f32 v47, v47
    v_mov_b32 v18, v45
    v_mul_f32 v19, v19, v47
    v_readlane_b32 s48, v47, 0
    v_readlane_b32 s49, v47, 4
    s_nop 0
    v_mov_b32 v45, s48
    v_mov_b32 v46, s49
    v_cndmask_b32 v45, v45, v46, s[72:73]
    v_mul_f32 v20, v20, v45
    v_mul_f32 v21, v21, v45
    v_mul_f32 v22, v22, v45
    v_mul_f32 v23, v23, v45
    s_nop 1
    s_branch L_back42
L_slow45:
    v_max_f32_dpp v45, v44, v44 quad_perm:[1,0,3,2] row_mask:0xf bank_mask:0xf
    s_nop 1
    v_max_f32_dpp v45, v45, v45 quad_perm:[2,3,0,1] row_mask:0xf bank_mask:0xf
    s_nop 1
    v_max_f32_dpp v45, v45, v45 row_ror:8 row_mask:0xf bank_mask:0xf
    v_mov_b32 v46, v45
    s_nop 1
    v_permlane16_swap_b32 v45, v46
    v_max_f32 v45, v45, v46
    v_mov_b32 v46, v45
    s_nop 1
    v_permlane32_swap_b32 v45, v46
    v_max3_f32 v45, v45, v46, v18
    v_sub_f32 v47, v18, v45
    v_mul_f32 v47, s39, v47
    v_exp_f32 v47, v47
    v_mov_b32 v18, v45
    v_mul_f32 v19, v19, v47
    v_readlane_b32 s48, v47, 0
    v_readlane_b32 s49, v47, 4
    s_nop 0
    v_mov_b32 v45, s48
    v_mov_b32 v46, s49
    v_cndmask_b32 v45, v45, v46, s[72:73]
    v_mul_f32 v20, v20, v45
    v_mul_f32 v21, v21, v45
    v_mul_f32 v22, v22, v45
    v_mul_f32 v23, v23, v45
    s_nop 1
    s_branch L_back46
L_slow49:
    v_max_f32_dpp v45, v44, v44 quad_perm:[1,0,3,2] row_mask:0xf bank_mask:0xf
    s_nop 1
    v_max_f32_dpp v45, v45, v45 quad_perm:[2,3,0,1] row_mask:0xf bank_mask:0xf
    s_nop 1
    v_max_f32_dpp v45, v45, v45 row_ror:8 row_mask:0xf bank_mask:0xf
    v_mov_b32 v46, v45
    s_nop 1
    v_permlane16_swap_b32 v45, v46
    v_max_f32 v45, v45, v46
    v_mov_b32 v46, v45
    s_nop 1
    v_permlane32_swap_b32 v45, v46
    v_max3_f32 v45, v45, v46, v18
    v_sub_f32 v47, v18, v45
    v_mul_f32 v47, s39, v47
    v_exp_f32 v47, v47
    v_mov_b32 v18, v45
    v_mul_f32 v19, v19, v47
    v_readlane_b32 s48, v47, 0
    v_readlane_b32 s49, v47, 4
    s_nop 0
    v_mov_b32 v45, s48
    v_mov_b32 v46, s49
    v_cndmask_b32 v45, v45, v46, s[72:73]
    v_mul_f32 v20, v20, v45
    v_mul_f32 v21, v21, v45
    v_mul_f32 v22, v22, v45
    v_mul_f32 v23, v23, v45
    s_nop 1
    s_branch L_back50
L_slow53:
    v_max_f32_dpp v45, v44, v44 quad_perm:[1,0,3,2] row_mask:0xf bank_mask:0xf
    s_nop 1
    v_max_f32_dpp v45, v45, v45 quad_perm:[2,3,0,1] row_mask:0xf bank_mask:0xf
    s_nop 1
    v_max_f32_dpp v45, v45, v45 row_ror:8 row_mask:0xf bank_mask:0xf
    v_mov_b32 v46, v45
    s_nop 1
    v_permlane16_swap_b32 v45, v46
    v_max_f32 v45, v45, v46
    v_mov_b32 v46, v45
    s_nop 1
    v_permlane32_swap_b32 v45, v46
    v_max3_f32 v45, v45, v46, v18
    v_sub_f32 v47, v18, v45
    v_mul_f32 v47, s39, v47
    v_exp_f32 v47, v47
    v_mov_b32 v18, v45
    v_mul_f32 v19, v19, v47
    v_readlane_b32 s48, v47, 0
    v_readlane_b32 s49, v47, 4
    s_nop 0
    v_mov_b32 v45, s48
    v_mov_b32 v46, s49
    v_cndmask_b32 v45, v45, v46, s[72:73]
    v_mul_f32 v20, v20, v45
    v_mul_f32 v21, v21, v45
    v_mul_f32 v22, v22, v45
    v_mul_f32 v23, v23, v45
    s_nop 1
    s_branch L_back54
L_slow61:
    v_max_f32_dpp v45, v44, v44 quad_perm:[1,0,3,2] row_mask:0xf bank_mask:0xf
    s_nop 1
    v_max_f32_dpp v45, v45, v45 quad_perm:[2,3,0,1] row_mask:0xf bank_mask:0xf
    s_nop 1
    v_max_f32_dpp v45, v45, v45 row_ror:8 row_mask:0xf bank_mask:0xf
    v_mov_b32 v46, v45
    s_nop 1
    v_permlane16_swap_b32 v45, v46
    v_max_f32 v45, v45, v46
    v_mov_b32 v46, v45
    s_nop 1
    v_permlane32_swap_b32 v45, v46
    v_max3_f32 v45, v45, v46, v18
    v_sub_f32 v47, v18, v45
    v_mul_f32 v47, s39, v47
    v_exp_f32 v47, v47
    v_mov_b32 v18, v45
    v_mul_f32 v19, v19, v47
    v_readlane_b32 s48, v47, 0
    v_readlane_b32 s49, v47, 4
    s_nop 0
    v_mov_b32 v45, s48
    v_mov_b32 v46, s49
    v_cndmask_b32 v45, v45, v46, s[72:73]
    v_mul_f32 v20, v20, v45
    v_mul_f32 v21, v21, v45
    v_mul_f32 v22, v22, v45
    v_mul_f32 v23, v23, v45
    s_nop 1
    s_branch L_back62
L_slow66:
    v_max_f32_dpp v45, v44, v44 quad_perm:[1,0,3,2] row_mask:0xf bank_mask:0xf
    s_nop 1
    v_max_f32_dpp v45, v45, v45 quad_perm:[2,3,0,1] row_mask:0xf bank_mask:0xf
    s_nop 1
    v_max_f32_dpp v45, v45, v45 row_ror:8 row_mask:0xf bank_mask:0xf
    v_mov_b32 v46, v45
    s_nop 1
    v_permlane16_swap_b32 v45, v46
    v_max_f32 v45, v45, v46
    v_mov_b32 v46, v45
    s_nop 1
    v_permlane32_swap_b32 v45, v46
    v_max3_f32 v45, v45, v46, v18
    v_sub_f32 v47, v18, v45
    v_mul_f32 v47, s39, v47
    v_exp_f32 v47, v47
    v_mov_b32 v18, v45
    v_mul_f32 v19, v19, v47
    v_readlane_b32 s48, v47, 0
    v_readlane_b32 s49, v47, 4
    s_nop 0
    v_mov_b32 v45, s48
    v_mov_b32 v46, s49
    v_cndmask_b32 v45, v45, v46, s[72:73]
    v_mul_f32 v20, v20, v45
    v_mul_f32 v21, v21, v45
    v_mul_f32 v22, v22, v45
    v_mul_f32 v23, v23, v45
    s_nop 1
    s_branch L_back67
L_slow69:
    v_max_f32_dpp v45, v44, v44 quad_perm:[1,0,3,2] row_mask:0xf bank_mask:0xf
    s_nop 1
    v_max_f32_dpp v45, v45, v45 quad_perm:[2,3,0,1] row_mask:0xf bank_mask:0xf
    s_nop 1
    v_max_f32_dpp v45, v45, v45 row_ror:8 row_mask:0xf bank_mask:0xf
    v_mov_b32 v46, v45
    s_nop 1
    v_permlane16_swap_b32 v45, v46
    v_max_f32 v45, v45, v46
    v_mov_b32 v46, v45
    s_nop 1
    v_permlane32_swap_b32 v45, v46
    v_max3_f32 v45, v45, v46, v18
    v_sub_f32 v47, v18, v45
    v_mul_f32 v47, s39, v47
    v_exp_f32 v47, v47
    v_mov_b32 v18, v45
    v_mul_f32 v19, v19, v47
    v_readlane_b32 s48, v47, 0
    v_readlane_b32 s49, v47, 4
    s_nop 0
    v_mov_b32 v45, s48
    v_mov_b32 v46, s49
    v_cndmask_b32 v45, v45, v46, s[72:73]
    v_mul_f32 v20, v20, v45
    v_mul_f32 v21, v21, v45
    v_mul_f32 v22, v22, v45
    v_mul_f32 v23, v23, v45
    s_nop 1
    s_branch L_back70
L_slow71:
    v_max_f32_dpp v45, v44, v44 quad_perm:[1,0,3,2] row_mask:0xf bank_mask:0xf
    s_nop 1
    v_max_f32_dpp v45, v45, v45 quad_perm:[2,3,0,1] row_mask:0xf bank_mask:0xf
    s_nop 1
    v_max_f32_dpp v45, v45, v45 row_ror:8 row_mask:0xf bank_mask:0xf
    v_mov_b32 v46, v45
    s_nop 1
    v_permlane16_swap_b32 v45, v46
    v_max_f32 v45, v45, v46
    v_mov_b32 v46, v45
    s_nop 1
    v_permlane32_swap_b32 v45, v46
    v_max3_f32 v45, v45, v46, v18
    v_sub_f32 v47, v18, v45
    v_mul_f32 v47, s39, v47
    v_exp_f32 v47, v47
    v_mov_b32 v18, v45
    v_mul_f32 v19, v19, v47
    v_readlane_b32 s48, v47, 0
    v_readlane_b32 s49, v47, 4
    s_nop 0
    v_mov_b32 v45, s48
    v_mov_b32 v46, s49
    v_cndmask_b32 v45, v45, v46, s[72:73]
    v_mul_f32 v20, v20, v45
    v_mul_f32 v21, v21, v45
    v_mul_f32 v22, v22, v45
    v_mul_f32 v23, v23, v45
    s_nop 1
    s_branch L_back72
L_codeend:
.section .rodata,"a"
.p2align 6
.amdhsa_kernel sequential_preLN__gqa_block_cached__glu_gated_swiglu__decode_kernel
  .amdhsa_next_free_vgpr 512
  .amdhsa_next_free_sgpr 102
  .amdhsa_accum_offset 256
  .amdhsa_group_segment_fixed_size 0
  .amdhsa_kernarg_size 96
  .amdhsa_user_sgpr_count 2
  .amdhsa_user_sgpr_kernarg_segment_ptr 1
  .amdhsa_system_sgpr_workgroup_id_x 1
  .amdhsa_float_denorm_mode_32 3
.end_amdhsa_kernel
```
